```python
import torch

def _softmax(x, axis=-1):
    return torch.softmax(x, dim=axis)
def _gelu(x):
    return torch.nn.functional.gelu(x, approximate="tanh")
def _silu(x):
    return torch.nn.functional.silu(x)
def _sigmoid(x):
    return torch.sigmoid(x)
def _layernorm(x, axis=-1, eps=1e-5):
    m = x.mean(dim=axis, keepdim=True)
    v = x.var(dim=axis, keepdim=True, unbiased=False)
    return (x - m) / torch.sqrt(v + eps)
def _scatter_add(tgt, idx, src, axis=0):
    return tgt.clone().index_add_(axis, idx, src)
def _segment_sum(src, seg, n):
    out = torch.zeros((n,) + src.shape[1:], dtype=src.dtype)
    return out.index_add_(0, seg, src)
def _pad(x, pw):
    flat = tuple(v for pair in reversed(pw) for v in pair)
    return torch.nn.functional.pad(x, flat)

kernel_name = 'parallel_sum__mha_block_cached__glu_gated_reglu__decode'

def setup_inputs():

    _w = (lambda a: (lambda t: t.to(torch.bfloat16) if t.is_floating_point() else t)(torch.as_tensor(a)))
    def _A_setup():
        B, Sq, D = 1, 1, 512
        H, Sk, Dh = 32, 65536, 128
        return {
            "x": _w((lambda *s: torch.randn(*s, dtype=torch.bfloat16) * 0.05)(B, Sq, D)),
            "k_cache": _w((lambda *s: torch.randn(*s, dtype=torch.bfloat16) * 3.2)(B, H, Sk, Dh)),
            "v_cache": _w((lambda *s: torch.randn(*s, dtype=torch.bfloat16) * 1.6)(B, H, Sk, Dh)),
            "wq": _w((lambda *s: torch.randn(*s, dtype=torch.bfloat16) * 3.2)(D, H * Dh) * (D ** -0.5)),
            "wo": _w((lambda *s: torch.randn(*s, dtype=torch.bfloat16) * 1.6)(H * Dh, D) * ((H * Dh) ** -0.5)),
        }
    _A_in = _A_setup()

    def _B_setup():
        B, S, D, F = 1, 1, 512, 1792
        return {
            "x": _w((lambda *s: torch.randn(*s, dtype=torch.bfloat16) * 0.05)(B, S, D)),
            "W_gate": _w((lambda *s: torch.randn(*s, dtype=torch.bfloat16) * 1.6)(D, F) * (2.0 / D) ** 0.5),
            "W_up": _w((lambda *s: torch.randn(*s, dtype=torch.bfloat16) * 1.6)(D, F) * (2.0 / D) ** 0.5),
            "W_down": _w((lambda *s: torch.randn(*s, dtype=torch.bfloat16) * 1.6)(F, D) * (1.0 / F) ** 0.5),
        }
    _B_in = _B_setup()

    return {
        "A_x": _A_in["x"],
        "A_k_cache": _A_in["k_cache"],
        "A_v_cache": _A_in["v_cache"],
        "A_wq": _A_in["wq"],
        "A_wo": _A_in["wo"],
        "B_x": _B_in["x"],
        "B_W_gate": _B_in["W_gate"],
        "B_W_up": _B_in["W_up"],
        "B_W_down": _B_in["W_down"],
    }

def reference(A_x, A_k_cache, A_v_cache, A_wq, A_wo, B_x, B_W_gate, B_W_up, B_W_down):
    def _A_ref(x, k_cache, v_cache, wq, wo):
        B, Sq, D = x.shape
        H, Dh = 32, 128
        q = (lambda x, *d: x.permute(*d))((x @ wq).reshape(B, Sq, H, Dh), 0, 2, 1, 3)
        scores = torch.einsum("bhqd,bhkd->bhqk", q, k_cache) * (Dh ** -0.5)
        p = _softmax(scores, axis=-1)
        o = torch.einsum("bhqk,bhkd->bhqd", p, v_cache)
        return (lambda x, *d: x.permute(*d))(o, 0, 2, 1, 3).reshape(B, Sq, H * Dh) @ wo

    def _B_ref(x, W_gate, W_up, W_down):
        gate = torch.einsum("bsd,df->bsf", x, W_gate)
        up = torch.einsum("bsd,df->bsf", x, W_up)
        gate = gate * (lambda x, dt: x.to(dt))(gate > 0, gate.dtype)
        h = gate * up
        return torch.einsum("bsf,fd->bsd", h, W_down)

    x = A_x
    xn = _layernorm(x, axis=-1)
    return x + _A_ref(xn, A_k_cache, A_v_cache, A_wq, A_wo) + _B_ref(xn, B_W_gate, B_W_up, B_W_down)
```

```asm
; @launch grid=(256,1,1) block=(192,1,1) lds=38400
.amdgcn_target "amdgcn-amd-amdhsa--gfx950"
.text
.globl parallel_sum__mha_block_cached__glu_gated_reglu__decode_kernel
.p2align 8
.type parallel_sum__mha_block_cached__glu_gated_reglu__decode_kernel,@function
parallel_sum__mha_block_cached__glu_gated_reglu__decode_kernel:
    s_cmp_ge_u32 s2, 256
    s_cbranch_scc1 L_end_parallel_sum__mha_block_
    s_load_dwordx16 s[4:19], s[0:1], 0
    s_load_dwordx8 s[20:27], s[0:1], 64
    v_lshrrev_b32 v2, 6, v0
    v_and_b32 v1, 63, v0
    v_readfirstlane_b32 s3, v2
    s_lshr_b32 s28, s2, 3
    s_and_b32 s29, s2, 7
    v_lshlrev_b32 v3, 4, v1
    s_cmp_eq_u32 s3, 2
    s_cbranch_scc1 L_aux_parallel_sum__mha_block_
    v_and_b32 v8, 3, v1
    v_lshlrev_b32 v2, 4, v8
    v_lshrrev_b32 v8, 4, v1
    v_lshl_add_u32 v2, v8, 6, v2
    v_bfe_i32 v9, v1, 2, 1
    v_and_b32 v9, 2187264, v9
    v_xor_b32 v2, v2, v9
    v_bfe_i32 v9, v1, 3, 1
    v_and_b32 v9, 49920, v9
    v_xor_b32 v2, v2, v9
    s_lshl_b32 s58, s28, 24
    s_mov_b32 s77, 0
    s_bitcmp1_b32 s28, 0
    s_cselect_b32 s57, 9681152, 0
    s_xor_b32 s77, s77, s57
    s_bitcmp1_b32 s28, 1
    s_cselect_b32 s57, 10443776, 0
    s_xor_b32 s77, s77, s57
    s_bitcmp1_b32 s28, 2
    s_cselect_b32 s57, 154112, 0
    s_xor_b32 s77, s77, s57
    s_bitcmp1_b32 s28, 3
    s_cselect_b32 s57, 1899264, 0
    s_xor_b32 s77, s77, s57
    s_bitcmp1_b32 s28, 4
    s_cselect_b32 s57, 14540288, 0
    s_xor_b32 s77, s77, s57
    s_mov_b32 s78, s77
    s_bitcmp1_b32 s29, 0
    s_cselect_b32 s57, 3734784, 0
    s_xor_b32 s78, s78, s57
    s_bitcmp1_b32 s29, 1
    s_cselect_b32 s57, 16222976, 0
    s_xor_b32 s78, s78, s57
    s_bitcmp1_b32 s29, 2
    s_cselect_b32 s57, 7785472, 0
    s_xor_b32 s78, s78, s57
    s_bitcmp1_b32 s3, 0
    s_cselect_b32 s57, 13607936, 0
    s_xor_b32 s78, s78, s57
    s_mov_b32 s34, 16777216
    s_mov_b32 s35, 0x20000
    s_waitcnt lgkmcnt(0)
    s_add_u32 s32, s6, s58
    s_addc_u32 s33, s7, 0
    v_xor_b32 v62, s78, v2
    buffer_load_dwordx4 v[64:67], v62, s[32:35], 0 offen nt
    s_xor_b32 s59, s78, 2146560
    v_xor_b32 v62, s59, v2
    buffer_load_dwordx4 v[68:71], v62, s[32:35], 0 offen nt
    s_xor_b32 s59, s78, 74240
    v_xor_b32 v62, s59, v2
    buffer_load_dwordx4 v[72:75], v62, s[32:35], 0 offen nt
    s_xor_b32 s59, s78, 2220800
    v_xor_b32 v62, s59, v2
    buffer_load_dwordx4 v[76:79], v62, s[32:35], 0 offen nt
    s_xor_b32 s59, s78, 123648
    v_xor_b32 v62, s59, v2
    buffer_load_dwordx4 v[80:83], v62, s[32:35], 0 offen nt
    s_xor_b32 s59, s78, 2171392
    v_xor_b32 v62, s59, v2
    buffer_load_dwordx4 v[84:87], v62, s[32:35], 0 offen nt
    s_xor_b32 s59, s78, 49408
    v_xor_b32 v62, s59, v2
    buffer_load_dwordx4 v[88:91], v62, s[32:35], 0 offen nt
    s_xor_b32 s59, s78, 2097152
    v_xor_b32 v62, s59, v2
    buffer_load_dwordx4 v[92:95], v62, s[32:35], 0 offen nt
    s_xor_b32 s59, s78, 14176768
    v_xor_b32 v62, s59, v2
    buffer_load_dwordx4 v[96:99], v62, s[32:35], 0 offen nt
    s_xor_b32 s59, s78, 16290560
    v_xor_b32 v62, s59, v2
    buffer_load_dwordx4 v[100:103], v62, s[32:35], 0 offen nt
    s_xor_b32 s59, s78, 14249984
    v_xor_b32 v62, s59, v2
    buffer_load_dwordx4 v[104:107], v62, s[32:35], 0 offen nt
    s_xor_b32 s59, s78, 16363776
    v_xor_b32 v62, s59, v2
    buffer_load_dwordx4 v[108:111], v62, s[32:35], 0 offen nt
    s_barrier
    s_load_dword s61, s[26:27], 1024000
    s_mov_b32 s30, 0x3db504f3
    s_mov_b32 s31, 0x3fb8aa3b
    s_mov_b32 s56, 0xffff0000
    s_mov_b32 s55, 0xffffffe0
    v_and_b32 v8, 1, v1
    v_lshlrev_b32 v8, 4, v8
    v_mov_b32 v9, 0xffff
    v_lshlrev_b32 v8, v8, v9
    v_bfe_u32 v9, v1, 1, 2
    v_cmp_eq_u32 vcc, 0, v9
    s_nop 1
    v_cndmask_b32 v4, 0, v8, vcc
    v_cmp_eq_u32 vcc, 1, v9
    s_nop 1
    v_cndmask_b32 v5, 0, v8, vcc
    v_cmp_eq_u32 vcc, 2, v9
    s_nop 1
    v_cndmask_b32 v6, 0, v8, vcc
    v_cmp_eq_u32 vcc, 3, v9
    s_nop 1
    v_cndmask_b32 v7, 0, v8, vcc
    s_add_u32 s36, s8, s58
    s_addc_u32 s37, s9, 0
    s_mov_b32 s38, 16777216
    s_mov_b32 s39, 0x20000
    v_and_b32 v22, 15, v1
    v_lshlrev_b32 v22, 4, v22
    v_bfe_i32 v9, v1, 4, 1
    v_and_b32 v9, 2187264, v9
    v_xor_b32 v22, v22, v9
    v_bfe_i32 v9, v1, 5, 1
    v_and_b32 v9, 49920, v9
    v_xor_b32 v22, v22, v9
    v_mov_b32 v61, 0
    v_bfe_i32 v9, v1, 0, 1
    v_and_b32 v9, 6825728, v9
    v_xor_b32 v61, v61, v9
    v_bfe_i32 v9, v1, 1, 1
    v_and_b32 v9, 9531648, v9
    v_xor_b32 v61, v61, v9
    v_bfe_i32 v9, v1, 2, 1
    v_and_b32 v9, 98560, v9
    v_xor_b32 v61, v61, v9
    v_bfe_i32 v9, v1, 3, 1
    v_and_b32 v9, 541696, v9
    v_xor_b32 v61, v61, v9
    v_bfe_i32 v9, v1, 4, 1
    v_and_b32 v9, 3757312, v9
    v_xor_b32 v61, v61, v9
    v_bfe_i32 v9, v1, 5, 1
    v_and_b32 v9, 11777536, v9
    v_xor_b32 v61, v61, v9
    s_mul_i32 s57, s28, 256
    s_add_u32 s57, s57, 655360
    s_add_u32 s40, s26, s57
    s_addc_u32 s41, s27, 0
    s_mov_b32 s42, 4
    s_mov_b32 s43, 0x20000
    v_and_b32 v12, 15, v1
    v_lshlrev_b32 v12, 5, v12
    v_and_b32 v13, 16, v1
    s_lshl_b32 s57, s3, 9
    v_add3_u32 v23, v12, v13, s57
    s_mul_i32 s57, s3, 16384
    v_lshlrev_b32 v26, 2, v1
    v_add_u32 v26, s57, v26
    v_mov_b32 v27, v26
    v_lshrrev_b32 v14, 2, v1
    v_lshlrev_b32 v14, 4, v14
    v_and_b32 v15, 3, v1
    v_mov_b32 v8, 0
    v_mov_b32 v9, 0
    v_mov_b32 v10, 0
    v_mov_b32 v11, 0
    v_mov_b32 v19, 0xff800000
    v_mov_b32 v21, 0
    v_mov_b32 v63, 0
    s_waitcnt vmcnt(8)
    s_xor_b32 s59, s78, 14266624
    v_xor_b32 v62, s59, v2
    buffer_load_dwordx4 v[112:115], v62, s[32:35], 0 offen nt
    s_xor_b32 s59, s78, 16347136
    v_xor_b32 v62, s59, v2
    buffer_load_dwordx4 v[116:119], v62, s[32:35], 0 offen nt
    s_xor_b32 s59, s78, 14193408
    v_xor_b32 v62, s59, v2
    buffer_load_dwordx4 v[120:123], v62, s[32:35], 0 offen nt
    s_xor_b32 s59, s78, 16273920
    v_xor_b32 v62, s59, v2
    buffer_load_dwordx4 v[124:127], v62, s[32:35], 0 offen nt
    s_waitcnt vmcnt(8)
    s_xor_b32 s59, s78, 6825728
    v_xor_b32 v62, s59, v2
    buffer_load_dwordx4 v[128:131], v62, s[32:35], 0 offen nt
    s_xor_b32 s59, s78, 4777472
    v_xor_b32 v62, s59, v2
    buffer_load_dwordx4 v[132:135], v62, s[32:35], 0 offen nt
    s_xor_b32 s59, s78, 6882560
    v_xor_b32 v62, s59, v2
    buffer_load_dwordx4 v[136:139], v62, s[32:35], 0 offen nt
    s_xor_b32 s59, s78, 4834304
    v_xor_b32 v62, s59, v2
    buffer_load_dwordx4 v[140:143], v62, s[32:35], 0 offen nt
    s_waitcnt vmcnt(8)
    s_xor_b32 s59, s78, 6931456
    v_xor_b32 v62, s59, v2
    buffer_load_dwordx4 v[144:147], v62, s[32:35], 0 offen nt
    s_xor_b32 s59, s78, 4785408
    v_xor_b32 v62, s59, v2
    buffer_load_dwordx4 v[148:151], v62, s[32:35], 0 offen nt
    s_xor_b32 s59, s78, 6874624
    v_xor_b32 v62, s59, v2
    buffer_load_dwordx4 v[152:155], v62, s[32:35], 0 offen nt
    s_xor_b32 s59, s78, 4728576
    v_xor_b32 v62, s59, v2
    buffer_load_dwordx4 v[156:159], v62, s[32:35], 0 offen nt
    s_waitcnt vmcnt(8)
    s_xor_b32 s59, s78, 11564288
    v_xor_b32 v62, s59, v2
    buffer_load_dwordx4 v[160:163], v62, s[32:35], 0 offen nt
    s_xor_b32 s59, s78, 9483264
    v_xor_b32 v62, s59, v2
    buffer_load_dwordx4 v[164:167], v62, s[32:35], 0 offen nt
    s_xor_b32 s59, s78, 11622144
    v_xor_b32 v62, s59, v2
    buffer_load_dwordx4 v[168:171], v62, s[32:35], 0 offen nt
    s_xor_b32 s59, s78, 9541120
    v_xor_b32 v62, s59, v2
    buffer_load_dwordx4 v[172:175], v62, s[32:35], 0 offen nt
    s_waitcnt vmcnt(8)
    s_xor_b32 s59, s78, 11638272
    v_xor_b32 v62, s59, v2
    buffer_load_dwordx4 v[176:179], v62, s[32:35], 0 offen nt
    s_xor_b32 s59, s78, 9524992
    v_xor_b32 v62, s59, v2
    buffer_load_dwordx4 v[180:183], v62, s[32:35], 0 offen nt
    s_xor_b32 s59, s78, 11580416
    v_xor_b32 v62, s59, v2
    buffer_load_dwordx4 v[184:187], v62, s[32:35], 0 offen nt
    s_xor_b32 s59, s78, 9467136
    v_xor_b32 v62, s59, v2
    buffer_load_dwordx4 v[188:191], v62, s[32:35], 0 offen nt
    s_waitcnt vmcnt(8)
    s_xor_b32 s59, s78, 9531648
    v_xor_b32 v62, s59, v2
    buffer_load_dwordx4 v[192:195], v62, s[32:35], 0 offen nt
    s_xor_b32 s59, s78, 11644928
    v_xor_b32 v62, s59, v2
    buffer_load_dwordx4 v[196:199], v62, s[32:35], 0 offen nt
    s_xor_b32 s59, s78, 9458432
    v_xor_b32 v62, s59, v2
    buffer_load_dwordx4 v[200:203], v62, s[32:35], 0 offen nt
    s_xor_b32 s59, s78, 11571712
    v_xor_b32 v62, s59, v2
    buffer_load_dwordx4 v[204:207], v62, s[32:35], 0 offen nt
    s_waitcnt vmcnt(8)
    s_xor_b32 s59, s78, 9474560
    v_xor_b32 v62, s59, v2
    buffer_load_dwordx4 v[208:211], v62, s[32:35], 0 offen nt
    s_xor_b32 s59, s78, 11555584
    v_xor_b32 v62, s59, v2
    buffer_load_dwordx4 v[212:215], v62, s[32:35], 0 offen nt
    s_xor_b32 s59, s78, 9547776
    v_xor_b32 v62, s59, v2
    buffer_load_dwordx4 v[216:219], v62, s[32:35], 0 offen nt
    s_xor_b32 s59, s78, 11628800
    v_xor_b32 v62, s59, v2
    buffer_load_dwordx4 v[220:223], v62, s[32:35], 0 offen nt
    s_waitcnt vmcnt(8)
    s_xor_b32 s59, s78, 4793088
    v_xor_b32 v62, s59, v2
    buffer_load_dwordx4 v[224:227], v62, s[32:35], 0 offen nt
    s_xor_b32 s59, s78, 6939136
    v_xor_b32 v62, s59, v2
    buffer_load_dwordx4 v[228:231], v62, s[32:35], 0 offen nt
    s_xor_b32 s59, s78, 4718848
    v_xor_b32 v62, s59, v2
    buffer_load_dwordx4 v[232:235], v62, s[32:35], 0 offen nt
    s_xor_b32 s59, s78, 6864896
    v_xor_b32 v62, s59, v2
    buffer_load_dwordx4 v[236:239], v62, s[32:35], 0 offen nt
    s_waitcnt vmcnt(8)
    s_xor_b32 s59, s78, 4767744
    v_xor_b32 v62, s59, v2
    buffer_load_dwordx4 v[240:243], v62, s[32:35], 0 offen nt
    s_xor_b32 s59, s78, 6816000
    v_xor_b32 v62, s59, v2
    buffer_load_dwordx4 v[244:247], v62, s[32:35], 0 offen nt
    s_xor_b32 s59, s78, 4841984
    v_xor_b32 v62, s59, v2
    buffer_load_dwordx4 v[248:251], v62, s[32:35], 0 offen nt
    s_xor_b32 s59, s78, 6890240
    v_xor_b32 v62, s59, v2
    buffer_load_dwordx4 v[252:255], v62, s[32:35], 0 offen nt
    s_waitcnt vmcnt(8)
    s_xor_b32 s59, s78, 16340480
    v_xor_b32 v62, s59, v2
    buffer_load_dwordx4 a[0:3], v62, s[32:35], 0 offen nt
    s_xor_b32 s59, s78, 14259968
    v_xor_b32 v62, s59, v2
    buffer_load_dwordx4 a[4:7], v62, s[32:35], 0 offen nt
    s_xor_b32 s59, s78, 16282624
    v_xor_b32 v62, s59, v2
    buffer_load_dwordx4 a[8:11], v62, s[32:35], 0 offen nt
    s_xor_b32 s59, s78, 14202112
    v_xor_b32 v62, s59, v2
    buffer_load_dwordx4 a[12:15], v62, s[32:35], 0 offen nt
    s_waitcnt vmcnt(8)
    s_xor_b32 s59, s78, 16299264
    v_xor_b32 v62, s59, v2
    buffer_load_dwordx4 a[16:19], v62, s[32:35], 0 offen nt
    s_xor_b32 s59, s78, 14185472
    v_xor_b32 v62, s59, v2
    buffer_load_dwordx4 a[20:23], v62, s[32:35], 0 offen nt
    s_xor_b32 s59, s78, 16357120
    v_xor_b32 v62, s59, v2
    buffer_load_dwordx4 a[24:27], v62, s[32:35], 0 offen nt
    s_xor_b32 s59, s78, 14243328
    v_xor_b32 v62, s59, v2
    buffer_load_dwordx4 a[28:31], v62, s[32:35], 0 offen nt
    s_waitcnt vmcnt(8)
    s_xor_b32 s59, s78, 2163712
    v_xor_b32 v62, s59, v2
    buffer_load_dwordx4 a[32:35], v62, s[32:35], 0 offen nt
    s_xor_b32 s59, s78, 115968
    v_xor_b32 v62, s59, v2
    buffer_load_dwordx4 a[36:39], v62, s[32:35], 0 offen nt
    s_xor_b32 s59, s78, 2106880
    v_xor_b32 v62, s59, v2
    buffer_load_dwordx4 a[40:43], v62, s[32:35], 0 offen nt
    s_xor_b32 s59, s78, 59136
    v_xor_b32 v62, s59, v2
    buffer_load_dwordx4 a[44:47], v62, s[32:35], 0 offen nt
    s_waitcnt vmcnt(8)
    s_xor_b32 s59, s78, 2156288
    v_xor_b32 v62, s59, v2
    buffer_load_dwordx4 a[48:51], v62, s[32:35], 0 offen nt
    s_xor_b32 s59, s78, 9728
    v_xor_b32 v62, s59, v2
    buffer_load_dwordx4 a[52:55], v62, s[32:35], 0 offen nt
    s_xor_b32 s59, s78, 2213120
    v_xor_b32 v62, s59, v2
    buffer_load_dwordx4 a[56:59], v62, s[32:35], 0 offen nt
    s_xor_b32 s59, s78, 66560
    v_xor_b32 v62, s59, v2
    buffer_load_dwordx4 a[60:63], v62, s[32:35], 0 offen nt
    s_waitcnt vmcnt(8)
    s_xor_b32 s59, s78, 98560
    v_xor_b32 v62, s59, v2
    buffer_load_dwordx4 a[64:67], v62, s[32:35], 0 offen nt
    s_xor_b32 s59, s78, 2179072
    v_xor_b32 v62, s59, v2
    buffer_load_dwordx4 a[68:71], v62, s[32:35], 0 offen nt
    s_xor_b32 s59, s78, 41728
    v_xor_b32 v62, s59, v2
    buffer_load_dwordx4 a[72:75], v62, s[32:35], 0 offen nt
    s_xor_b32 s59, s78, 2122240
    v_xor_b32 v62, s59, v2
    buffer_load_dwordx4 a[76:79], v62, s[32:35], 0 offen nt
    s_waitcnt vmcnt(8)
    s_xor_b32 s59, s78, 25088
    v_xor_b32 v62, s59, v2
    buffer_load_dwordx4 a[80:83], v62, s[32:35], 0 offen nt
    s_xor_b32 s59, s78, 2138880
    v_xor_b32 v62, s59, v2
    buffer_load_dwordx4 a[84:87], v62, s[32:35], 0 offen nt
    s_xor_b32 s59, s78, 81920
    v_xor_b32 v62, s59, v2
    buffer_load_dwordx4 a[88:91], v62, s[32:35], 0 offen nt
    s_xor_b32 s59, s78, 2195712
    v_xor_b32 v62, s59, v2
    buffer_load_dwordx4 a[92:95], v62, s[32:35], 0 offen nt
    s_waitcnt vmcnt(8)
    s_xor_b32 s59, s78, 14275328
    v_xor_b32 v62, s59, v2
    buffer_load_dwordx4 a[96:99], v62, s[32:35], 0 offen nt
    s_xor_b32 s59, s78, 16323072
    v_xor_b32 v62, s59, v2
    buffer_load_dwordx4 a[100:103], v62, s[32:35], 0 offen nt
    s_xor_b32 s59, s78, 14217472
    v_xor_b32 v62, s59, v2
    buffer_load_dwordx4 a[104:107], v62, s[32:35], 0 offen nt
    s_xor_b32 s59, s78, 16265216
    v_xor_b32 v62, s59, v2
    buffer_load_dwordx4 a[108:111], v62, s[32:35], 0 offen nt
    s_waitcnt vmcnt(8)
    s_xor_b32 s59, s78, 14168064
    v_xor_b32 v62, s59, v2
    buffer_load_dwordx4 a[112:115], v62, s[32:35], 0 offen nt
    s_xor_b32 s59, s78, 16314624
    v_xor_b32 v62, s59, v2
    buffer_load_dwordx4 a[116:119], v62, s[32:35], 0 offen nt
    s_xor_b32 s59, s78, 14225920
    v_xor_b32 v62, s59, v2
    buffer_load_dwordx4 a[120:123], v62, s[32:35], 0 offen nt
    s_xor_b32 s59, s78, 16372480
    v_xor_b32 v62, s59, v2
    buffer_load_dwordx4 a[124:127], v62, s[32:35], 0 offen nt
    s_waitcnt vmcnt(8)
    s_xor_b32 s59, s78, 6923776
    v_xor_b32 v62, s59, v2
    buffer_load_dwordx4 a[128:131], v62, s[32:35], 0 offen nt
    s_xor_b32 s59, s78, 4810496
    v_xor_b32 v62, s59, v2
    buffer_load_dwordx4 a[132:135], v62, s[32:35], 0 offen nt
    s_xor_b32 s59, s78, 6849536
    v_xor_b32 v62, s59, v2
    buffer_load_dwordx4 a[136:139], v62, s[32:35], 0 offen nt
    s_xor_b32 s59, s78, 4736256
    v_xor_b32 v62, s59, v2
    buffer_load_dwordx4 a[140:143], v62, s[32:35], 0 offen nt
    s_waitcnt vmcnt(8)
    s_xor_b32 s59, s78, 6833408
    v_xor_b32 v62, s59, v2
    buffer_load_dwordx4 a[144:147], v62, s[32:35], 0 offen nt
    s_xor_b32 s59, s78, 4752384
    v_xor_b32 v62, s59, v2
    buffer_load_dwordx4 a[148:151], v62, s[32:35], 0 offen nt
    s_xor_b32 s59, s78, 6907648
    v_xor_b32 v62, s59, v2
    buffer_load_dwordx4 a[152:155], v62, s[32:35], 0 offen nt
    s_xor_b32 s59, s78, 4826624
    v_xor_b32 v62, s59, v2
    buffer_load_dwordx4 a[156:159], v62, s[32:35], 0 offen nt
    s_waitcnt vmcnt(8)
    s_xor_b32 s59, s78, 11662336
    v_xor_b32 v62, s59, v2
    buffer_load_dwordx4 a[160:163], v62, s[32:35], 0 offen nt
    s_xor_b32 s59, s78, 9516288
    v_xor_b32 v62, s59, v2
    buffer_load_dwordx4 a[164:167], v62, s[32:35], 0 offen nt
    s_xor_b32 s59, s78, 11589120
    v_xor_b32 v62, s59, v2
    buffer_load_dwordx4 a[168:171], v62, s[32:35], 0 offen nt
    s_xor_b32 s59, s78, 9443072
    v_xor_b32 v62, s59, v2
    buffer_load_dwordx4 a[172:175], v62, s[32:35], 0 offen nt
    s_waitcnt vmcnt(8)
    s_xor_b32 s59, s78, 11540224
    v_xor_b32 v62, s59, v2
    buffer_load_dwordx4 a[176:179], v62, s[32:35], 0 offen nt
    s_xor_b32 s59, s78, 9491968
    v_xor_b32 v62, s59, v2
    buffer_load_dwordx4 a[180:183], v62, s[32:35], 0 offen nt
    s_xor_b32 s59, s78, 11613440
    v_xor_b32 v62, s59, v2
    buffer_load_dwordx4 a[184:187], v62, s[32:35], 0 offen nt
    s_xor_b32 s59, s78, 9565184
    v_xor_b32 v62, s59, v2
    buffer_load_dwordx4 a[188:191], v62, s[32:35], 0 offen nt
    s_mov_b32 s60, 2400000
L_qwait_parallel_sum__mha_block_:
    ds_read_b32 v16, v63 offset:4644
    ds_read_b128 v[28:31], v14 offset:2048
    s_waitcnt lgkmcnt(0)
    v_cmp_ne_u32 vcc, 1, v16
    s_cbranch_vccz L_qhere_parallel_sum__mha_block_
    s_sub_u32 s60, s60, 1
    s_cmp_lg_u32 s60, 0
    s_cbranch_scc1 L_qwait_parallel_sum__mha_block_
L_qhere_parallel_sum__mha_block_:
    v_cmp_eq_u32 vcc, 0, v15
    s_nop 1
    v_cndmask_b32 v44, 0, v28, vcc
    v_cndmask_b32 v45, 0, v29, vcc
    v_cndmask_b32 v46, 0, v30, vcc
    v_cndmask_b32 v47, 0, v31, vcc
    v_cmp_eq_u32 vcc, 1, v15
    s_nop 1
    v_cndmask_b32 v48, 0, v28, vcc
    v_cndmask_b32 v49, 0, v29, vcc
    v_cndmask_b32 v50, 0, v30, vcc
    v_cndmask_b32 v51, 0, v31, vcc
    v_cmp_eq_u32 vcc, 2, v15
    s_nop 1
    v_cndmask_b32 v52, 0, v28, vcc
    v_cndmask_b32 v53, 0, v29, vcc
    v_cndmask_b32 v54, 0, v30, vcc
    v_cndmask_b32 v55, 0, v31, vcc
    v_cmp_eq_u32 vcc, 3, v15
    s_nop 1
    v_cndmask_b32 v56, 0, v28, vcc
    v_cndmask_b32 v57, 0, v29, vcc
    v_cndmask_b32 v58, 0, v30, vcc
    v_cndmask_b32 v59, 0, v31, vcc
    s_waitcnt vmcnt(63)
    v_mfma_f32_16x16x32_bf16 v[12:15], v[64:67], v[44:47], 0
    v_mfma_f32_16x16x32_bf16 v[12:15], v[68:71], v[48:51], v[12:15]
    v_mfma_f32_16x16x32_bf16 v[12:15], v[72:75], v[52:55], v[12:15]
    v_mfma_f32_16x16x32_bf16 v[12:15], v[76:79], v[56:59], v[12:15]
    s_nop 7
    v_mov_b32_dpp v12, v13 quad_perm:[0,1,2,3] row_mask:0xf bank_mask:0x2
    v_mov_b32_dpp v12, v14 quad_perm:[0,1,2,3] row_mask:0xf bank_mask:0x4
    v_mov_b32_dpp v12, v15 quad_perm:[0,1,2,3] row_mask:0xf bank_mask:0x8
    s_nop 1
    v_add_f32_dpp v12, v12, v12 row_ror:4 row_mask:0xf bank_mask:0xf
    s_nop 1
    v_add_f32_dpp v18, v12, v12 row_ror:8 row_mask:0xf bank_mask:0x1
    s_waitcnt vmcnt(63)
    v_mfma_f32_16x16x32_bf16 v[12:15], v[80:83], v[44:47], 0
    v_mfma_f32_16x16x32_bf16 v[12:15], v[84:87], v[48:51], v[12:15]
    v_mfma_f32_16x16x32_bf16 v[12:15], v[88:91], v[52:55], v[12:15]
    v_mfma_f32_16x16x32_bf16 v[12:15], v[92:95], v[56:59], v[12:15]
    s_nop 7
    v_mov_b32_dpp v12, v13 quad_perm:[0,1,2,3] row_mask:0xf bank_mask:0x2
    v_mov_b32_dpp v12, v14 quad_perm:[0,1,2,3] row_mask:0xf bank_mask:0x4
    v_mov_b32_dpp v12, v15 quad_perm:[0,1,2,3] row_mask:0xf bank_mask:0x8
    s_nop 1
    v_add_f32_dpp v12, v12, v12 row_ror:4 row_mask:0xf bank_mask:0xf
    s_nop 1
    v_add_f32_dpp v18, v12, v12 row_ror:8 row_mask:0xf bank_mask:0x2
    s_waitcnt vmcnt(63)
    v_mfma_f32_16x16x32_bf16 v[12:15], v[96:99], v[44:47], 0
    v_mfma_f32_16x16x32_bf16 v[12:15], v[100:103], v[48:51], v[12:15]
    v_mfma_f32_16x16x32_bf16 v[12:15], v[104:107], v[52:55], v[12:15]
    v_mfma_f32_16x16x32_bf16 v[12:15], v[108:111], v[56:59], v[12:15]
    s_nop 7
    v_mov_b32_dpp v12, v13 quad_perm:[0,1,2,3] row_mask:0xf bank_mask:0x2
    v_mov_b32_dpp v12, v14 quad_perm:[0,1,2,3] row_mask:0xf bank_mask:0x4
    v_mov_b32_dpp v12, v15 quad_perm:[0,1,2,3] row_mask:0xf bank_mask:0x8
    s_nop 1
    v_add_f32_dpp v12, v12, v12 row_ror:4 row_mask:0xf bank_mask:0xf
    s_nop 1
    v_add_f32_dpp v18, v12, v12 row_ror:8 row_mask:0xf bank_mask:0x4
    s_waitcnt vmcnt(63)
    v_mfma_f32_16x16x32_bf16 v[12:15], v[112:115], v[44:47], 0
    v_mfma_f32_16x16x32_bf16 v[12:15], v[116:119], v[48:51], v[12:15]
    v_mfma_f32_16x16x32_bf16 v[12:15], v[120:123], v[52:55], v[12:15]
    v_mfma_f32_16x16x32_bf16 v[12:15], v[124:127], v[56:59], v[12:15]
    s_nop 7
    v_mov_b32_dpp v12, v13 quad_perm:[0,1,2,3] row_mask:0xf bank_mask:0x2
    v_mov_b32_dpp v12, v14 quad_perm:[0,1,2,3] row_mask:0xf bank_mask:0x4
    v_mov_b32_dpp v12, v15 quad_perm:[0,1,2,3] row_mask:0xf bank_mask:0x8
    s_nop 1
    v_add_f32_dpp v12, v12, v12 row_ror:4 row_mask:0xf bank_mask:0xf
    s_nop 1
    v_add_f32_dpp v18, v12, v12 row_ror:8 row_mask:0xf bank_mask:0x8
    v_cvt_pk_bf16_f32 v16, v18, v18
    v_and_b32 v16, s56, v16
    v_mul_f32 v16, s30, v16
    v_cvt_pk_bf16_f32 v16, v16, v16
    v_and_b32 v16, s56, v16
    v_max_f32 v19, v19, v16
    ds_write_b32 v26, v16 offset:5632
    v_add_u32 v26, 0x100, v26
    s_waitcnt vmcnt(63)
    v_mfma_f32_16x16x32_bf16 v[12:15], v[128:131], v[44:47], 0
    v_mfma_f32_16x16x32_bf16 v[12:15], v[132:135], v[48:51], v[12:15]
    v_mfma_f32_16x16x32_bf16 v[12:15], v[136:139], v[52:55], v[12:15]
    v_mfma_f32_16x16x32_bf16 v[12:15], v[140:143], v[56:59], v[12:15]
    s_xor_b32 s59, s78, 9498624
    v_xor_b32 v62, s59, v2
    buffer_load_dwordx4 v[128:131], v62, s[32:35], 0 offen nt
    s_xor_b32 s59, s78, 11546880
    v_xor_b32 v62, s59, v2
    buffer_load_dwordx4 v[132:135], v62, s[32:35], 0 offen nt
    s_xor_b32 s59, s78, 9556480
    v_xor_b32 v62, s59, v2
    buffer_load_dwordx4 v[136:139], v62, s[32:35], 0 offen nt
    s_xor_b32 s59, s78, 11604736
    v_xor_b32 v62, s59, v2
    buffer_load_dwordx4 v[140:143], v62, s[32:35], 0 offen nt
    v_mov_b32_dpp v12, v13 quad_perm:[0,1,2,3] row_mask:0xf bank_mask:0x2
    v_mov_b32_dpp v12, v14 quad_perm:[0,1,2,3] row_mask:0xf bank_mask:0x4
    v_mov_b32_dpp v12, v15 quad_perm:[0,1,2,3] row_mask:0xf bank_mask:0x8
    s_nop 1
    v_add_f32_dpp v12, v12, v12 row_ror:4 row_mask:0xf bank_mask:0xf
    s_nop 1
    v_add_f32_dpp v18, v12, v12 row_ror:8 row_mask:0xf bank_mask:0x1
    s_waitcnt vmcnt(63)
    v_mfma_f32_16x16x32_bf16 v[12:15], v[144:147], v[44:47], 0
    v_mfma_f32_16x16x32_bf16 v[12:15], v[148:151], v[48:51], v[12:15]
    v_mfma_f32_16x16x32_bf16 v[12:15], v[152:155], v[52:55], v[12:15]
    v_mfma_f32_16x16x32_bf16 v[12:15], v[156:159], v[56:59], v[12:15]
    s_nop 7
    v_mov_b32_dpp v12, v13 quad_perm:[0,1,2,3] row_mask:0xf bank_mask:0x2
    v_mov_b32_dpp v12, v14 quad_perm:[0,1,2,3] row_mask:0xf bank_mask:0x4
    v_mov_b32_dpp v12, v15 quad_perm:[0,1,2,3] row_mask:0xf bank_mask:0x8
    s_nop 1
    v_add_f32_dpp v12, v12, v12 row_ror:4 row_mask:0xf bank_mask:0xf
    s_nop 1
    v_add_f32_dpp v18, v12, v12 row_ror:8 row_mask:0xf bank_mask:0x2
    s_waitcnt vmcnt(63)
    v_mfma_f32_16x16x32_bf16 v[12:15], v[160:163], v[44:47], 0
    v_mfma_f32_16x16x32_bf16 v[12:15], v[164:167], v[48:51], v[12:15]
    v_mfma_f32_16x16x32_bf16 v[12:15], v[168:171], v[52:55], v[12:15]
    v_mfma_f32_16x16x32_bf16 v[12:15], v[172:175], v[56:59], v[12:15]
    s_xor_b32 s59, s78, 9507584
    v_xor_b32 v62, s59, v2
    buffer_load_dwordx4 v[144:147], v62, s[32:35], 0 offen nt
    s_xor_b32 s59, s78, 11653632
    v_xor_b32 v62, s59, v2
    buffer_load_dwordx4 v[148:151], v62, s[32:35], 0 offen nt
    s_xor_b32 s59, s78, 9449728
    v_xor_b32 v62, s59, v2
    buffer_load_dwordx4 v[152:155], v62, s[32:35], 0 offen nt
    s_xor_b32 s59, s78, 11595776
    v_xor_b32 v62, s59, v2
    buffer_load_dwordx4 v[156:159], v62, s[32:35], 0 offen nt
    v_mov_b32_dpp v12, v13 quad_perm:[0,1,2,3] row_mask:0xf bank_mask:0x2
    v_mov_b32_dpp v12, v14 quad_perm:[0,1,2,3] row_mask:0xf bank_mask:0x4
    v_mov_b32_dpp v12, v15 quad_perm:[0,1,2,3] row_mask:0xf bank_mask:0x8
    s_nop 1
    v_add_f32_dpp v12, v12, v12 row_ror:4 row_mask:0xf bank_mask:0xf
    s_nop 1
    v_add_f32_dpp v18, v12, v12 row_ror:8 row_mask:0xf bank_mask:0x4
    s_waitcnt vmcnt(63)
    v_mfma_f32_16x16x32_bf16 v[12:15], v[176:179], v[44:47], 0
    v_mfma_f32_16x16x32_bf16 v[12:15], v[180:183], v[48:51], v[12:15]
    v_mfma_f32_16x16x32_bf16 v[12:15], v[184:187], v[52:55], v[12:15]
    v_mfma_f32_16x16x32_bf16 v[12:15], v[188:191], v[56:59], v[12:15]
    s_nop 7
    v_mov_b32_dpp v12, v13 quad_perm:[0,1,2,3] row_mask:0xf bank_mask:0x2
    v_mov_b32_dpp v12, v14 quad_perm:[0,1,2,3] row_mask:0xf bank_mask:0x4
    v_mov_b32_dpp v12, v15 quad_perm:[0,1,2,3] row_mask:0xf bank_mask:0x8
    s_nop 1
    v_add_f32_dpp v12, v12, v12 row_ror:4 row_mask:0xf bank_mask:0xf
    s_nop 1
    v_add_f32_dpp v18, v12, v12 row_ror:8 row_mask:0xf bank_mask:0x8
    v_cvt_pk_bf16_f32 v16, v18, v18
    v_and_b32 v16, s56, v16
    v_mul_f32 v16, s30, v16
    v_cvt_pk_bf16_f32 v16, v16, v16
    v_and_b32 v16, s56, v16
    v_max_f32 v19, v19, v16
    ds_write_b32 v26, v16 offset:5632
    v_add_u32 v26, 0x100, v26
    s_waitcnt vmcnt(63)
    v_mfma_f32_16x16x32_bf16 v[12:15], v[192:195], v[44:47], 0
    v_mfma_f32_16x16x32_bf16 v[12:15], v[196:199], v[48:51], v[12:15]
    v_mfma_f32_16x16x32_bf16 v[12:15], v[200:203], v[52:55], v[12:15]
    v_mfma_f32_16x16x32_bf16 v[12:15], v[204:207], v[56:59], v[12:15]
    s_xor_b32 s59, s78, 4760064
    v_xor_b32 v62, s59, v2
    buffer_load_dwordx4 v[160:163], v62, s[32:35], 0 offen nt
    s_xor_b32 s59, s78, 6841088
    v_xor_b32 v62, s59, v2
    buffer_load_dwordx4 v[164:167], v62, s[32:35], 0 offen nt
    s_xor_b32 s59, s78, 4816896
    v_xor_b32 v62, s59, v2
    buffer_load_dwordx4 v[168:171], v62, s[32:35], 0 offen nt
    s_xor_b32 s59, s78, 6897920
    v_xor_b32 v62, s59, v2
    buffer_load_dwordx4 v[172:175], v62, s[32:35], 0 offen nt
    v_mov_b32_dpp v12, v13 quad_perm:[0,1,2,3] row_mask:0xf bank_mask:0x2
    v_mov_b32_dpp v12, v14 quad_perm:[0,1,2,3] row_mask:0xf bank_mask:0x4
    v_mov_b32_dpp v12, v15 quad_perm:[0,1,2,3] row_mask:0xf bank_mask:0x8
    s_nop 1
    v_add_f32_dpp v12, v12, v12 row_ror:4 row_mask:0xf bank_mask:0xf
    s_nop 1
    v_add_f32_dpp v18, v12, v12 row_ror:8 row_mask:0xf bank_mask:0x1
    s_waitcnt vmcnt(63)
    v_mfma_f32_16x16x32_bf16 v[12:15], v[208:211], v[44:47], 0
    v_mfma_f32_16x16x32_bf16 v[12:15], v[212:215], v[48:51], v[12:15]
    v_mfma_f32_16x16x32_bf16 v[12:15], v[216:219], v[52:55], v[12:15]
    v_mfma_f32_16x16x32_bf16 v[12:15], v[220:223], v[56:59], v[12:15]
    s_nop 7
    v_mov_b32_dpp v12, v13 quad_perm:[0,1,2,3] row_mask:0xf bank_mask:0x2
    v_mov_b32_dpp v12, v14 quad_perm:[0,1,2,3] row_mask:0xf bank_mask:0x4
    v_mov_b32_dpp v12, v15 quad_perm:[0,1,2,3] row_mask:0xf bank_mask:0x8
    s_nop 1
    v_add_f32_dpp v12, v12, v12 row_ror:4 row_mask:0xf bank_mask:0xf
    s_nop 1
    v_add_f32_dpp v18, v12, v12 row_ror:8 row_mask:0xf bank_mask:0x2
    s_waitcnt vmcnt(63)
    v_mfma_f32_16x16x32_bf16 v[12:15], v[224:227], v[44:47], 0
    v_mfma_f32_16x16x32_bf16 v[12:15], v[228:231], v[48:51], v[12:15]
    v_mfma_f32_16x16x32_bf16 v[12:15], v[232:235], v[52:55], v[12:15]
    v_mfma_f32_16x16x32_bf16 v[12:15], v[236:239], v[56:59], v[12:15]
    s_nop 7
    v_mov_b32_dpp v12, v13 quad_perm:[0,1,2,3] row_mask:0xf bank_mask:0x2
    v_mov_b32_dpp v12, v14 quad_perm:[0,1,2,3] row_mask:0xf bank_mask:0x4
    v_mov_b32_dpp v12, v15 quad_perm:[0,1,2,3] row_mask:0xf bank_mask:0x8
    s_nop 1
    v_add_f32_dpp v12, v12, v12 row_ror:4 row_mask:0xf bank_mask:0xf
    s_nop 1
    v_add_f32_dpp v18, v12, v12 row_ror:8 row_mask:0xf bank_mask:0x4
    s_waitcnt vmcnt(60)
    v_mfma_f32_16x16x32_bf16 v[12:15], v[240:243], v[44:47], 0
    v_mfma_f32_16x16x32_bf16 v[12:15], v[244:247], v[48:51], v[12:15]
    v_mfma_f32_16x16x32_bf16 v[12:15], v[248:251], v[52:55], v[12:15]
    v_mfma_f32_16x16x32_bf16 v[12:15], v[252:255], v[56:59], v[12:15]
    s_xor_b32 s59, s78, 4800768
    v_xor_b32 v62, s59, v2
    buffer_load_dwordx4 v[176:179], v62, s[32:35], 0 offen nt
    s_xor_b32 s59, s78, 6914048
    v_xor_b32 v62, s59, v2
    buffer_load_dwordx4 v[180:183], v62, s[32:35], 0 offen nt
    s_xor_b32 s59, s78, 4743936
    v_xor_b32 v62, s59, v2
    buffer_load_dwordx4 v[184:187], v62, s[32:35], 0 offen nt
    s_xor_b32 s59, s78, 6857216
    v_xor_b32 v62, s59, v2
    buffer_load_dwordx4 v[188:191], v62, s[32:35], 0 offen nt
    v_mov_b32_dpp v12, v13 quad_perm:[0,1,2,3] row_mask:0xf bank_mask:0x2
    v_mov_b32_dpp v12, v14 quad_perm:[0,1,2,3] row_mask:0xf bank_mask:0x4
    v_mov_b32_dpp v12, v15 quad_perm:[0,1,2,3] row_mask:0xf bank_mask:0x8
    s_nop 1
    v_add_f32_dpp v12, v12, v12 row_ror:4 row_mask:0xf bank_mask:0xf
    s_nop 1
    v_add_f32_dpp v18, v12, v12 row_ror:8 row_mask:0xf bank_mask:0x8
    v_cvt_pk_bf16_f32 v16, v18, v18
    v_and_b32 v16, s56, v16
    v_mul_f32 v16, s30, v16
    v_cvt_pk_bf16_f32 v16, v16, v16
    v_and_b32 v16, s56, v16
    v_max_f32 v19, v19, v16
    ds_write_b32 v26, v16 offset:5632
    v_add_u32 v26, 0x100, v26
    s_waitcnt vmcnt(60)
    v_mfma_f32_16x16x32_bf16 v[12:15], a[0:3], v[44:47], 0
    v_mfma_f32_16x16x32_bf16 v[12:15], a[4:7], v[48:51], v[12:15]
    v_mfma_f32_16x16x32_bf16 v[12:15], a[8:11], v[52:55], v[12:15]
    v_mfma_f32_16x16x32_bf16 v[12:15], a[12:15], v[56:59], v[12:15]
    s_nop 7
    v_mov_b32_dpp v12, v13 quad_perm:[0,1,2,3] row_mask:0xf bank_mask:0x2
    v_mov_b32_dpp v12, v14 quad_perm:[0,1,2,3] row_mask:0xf bank_mask:0x4
    v_mov_b32_dpp v12, v15 quad_perm:[0,1,2,3] row_mask:0xf bank_mask:0x8
    s_nop 1
    v_add_f32_dpp v12, v12, v12 row_ror:4 row_mask:0xf bank_mask:0xf
    s_nop 1
    v_add_f32_dpp v18, v12, v12 row_ror:8 row_mask:0xf bank_mask:0x1
    s_waitcnt vmcnt(56)
    v_mfma_f32_16x16x32_bf16 v[12:15], a[16:19], v[44:47], 0
    v_mfma_f32_16x16x32_bf16 v[12:15], a[20:23], v[48:51], v[12:15]
    v_mfma_f32_16x16x32_bf16 v[12:15], a[24:27], v[52:55], v[12:15]
    v_mfma_f32_16x16x32_bf16 v[12:15], a[28:31], v[56:59], v[12:15]
    s_xor_b32 s59, s78, 16307968
    v_xor_b32 v62, s59, v2
    buffer_load_dwordx4 v[192:195], v62, s[32:35], 0 offen nt
    s_xor_b32 s59, s78, 14161408
    v_xor_b32 v62, s59, v2
    buffer_load_dwordx4 v[196:199], v62, s[32:35], 0 offen nt
    s_xor_b32 s59, s78, 16381184
    v_xor_b32 v62, s59, v2
    buffer_load_dwordx4 v[200:203], v62, s[32:35], 0 offen nt
    s_xor_b32 s59, s78, 14234624
    v_xor_b32 v62, s59, v2
    buffer_load_dwordx4 v[204:207], v62, s[32:35], 0 offen nt
    v_mov_b32_dpp v12, v13 quad_perm:[0,1,2,3] row_mask:0xf bank_mask:0x2
    v_mov_b32_dpp v12, v14 quad_perm:[0,1,2,3] row_mask:0xf bank_mask:0x4
    v_mov_b32_dpp v12, v15 quad_perm:[0,1,2,3] row_mask:0xf bank_mask:0x8
    s_nop 1
    v_add_f32_dpp v12, v12, v12 row_ror:4 row_mask:0xf bank_mask:0xf
    s_nop 1
    v_add_f32_dpp v18, v12, v12 row_ror:8 row_mask:0xf bank_mask:0x2
    s_waitcnt vmcnt(56)
    v_mfma_f32_16x16x32_bf16 v[12:15], a[32:35], v[44:47], 0
    v_mfma_f32_16x16x32_bf16 v[12:15], a[36:39], v[48:51], v[12:15]
    v_mfma_f32_16x16x32_bf16 v[12:15], a[40:43], v[52:55], v[12:15]
    v_mfma_f32_16x16x32_bf16 v[12:15], a[44:47], v[56:59], v[12:15]
    s_nop 7
    v_mov_b32_dpp v12, v13 quad_perm:[0,1,2,3] row_mask:0xf bank_mask:0x2
    v_mov_b32_dpp v12, v14 quad_perm:[0,1,2,3] row_mask:0xf bank_mask:0x4
    v_mov_b32_dpp v12, v15 quad_perm:[0,1,2,3] row_mask:0xf bank_mask:0x8
    s_nop 1
    v_add_f32_dpp v12, v12, v12 row_ror:4 row_mask:0xf bank_mask:0xf
    s_nop 1
    v_add_f32_dpp v18, v12, v12 row_ror:8 row_mask:0xf bank_mask:0x4
    s_waitcnt vmcnt(52)
    v_mfma_f32_16x16x32_bf16 v[12:15], a[48:51], v[44:47], 0
    v_mfma_f32_16x16x32_bf16 v[12:15], a[52:55], v[48:51], v[12:15]
    v_mfma_f32_16x16x32_bf16 v[12:15], a[56:59], v[52:55], v[12:15]
    v_mfma_f32_16x16x32_bf16 v[12:15], a[60:63], v[56:59], v[12:15]
    s_xor_b32 s59, s78, 16331776
    v_xor_b32 v62, s59, v2
    buffer_load_dwordx4 v[208:211], v62, s[32:35], 0 offen nt
    s_xor_b32 s59, s78, 14284032
    v_xor_b32 v62, s59, v2
    buffer_load_dwordx4 v[212:215], v62, s[32:35], 0 offen nt
    s_xor_b32 s59, s78, 16258560
    v_xor_b32 v62, s59, v2
    buffer_load_dwordx4 v[216:219], v62, s[32:35], 0 offen nt
    s_xor_b32 s59, s78, 14210816
    v_xor_b32 v62, s59, v2
    buffer_load_dwordx4 v[220:223], v62, s[32:35], 0 offen nt
    v_mov_b32_dpp v12, v13 quad_perm:[0,1,2,3] row_mask:0xf bank_mask:0x2
    v_mov_b32_dpp v12, v14 quad_perm:[0,1,2,3] row_mask:0xf bank_mask:0x4
    v_mov_b32_dpp v12, v15 quad_perm:[0,1,2,3] row_mask:0xf bank_mask:0x8
    s_nop 1
    v_add_f32_dpp v12, v12, v12 row_ror:4 row_mask:0xf bank_mask:0xf
    s_nop 1
    v_add_f32_dpp v18, v12, v12 row_ror:8 row_mask:0xf bank_mask:0x8
    v_cvt_pk_bf16_f32 v16, v18, v18
    v_and_b32 v16, s56, v16
    v_mul_f32 v16, s30, v16
    v_cvt_pk_bf16_f32 v16, v16, v16
    v_and_b32 v16, s56, v16
    v_max_f32 v19, v19, v16
    ds_write_b32 v26, v16 offset:5632
    v_add_u32 v26, 0x100, v26
    s_waitcnt vmcnt(52)
    v_mfma_f32_16x16x32_bf16 v[12:15], a[64:67], v[44:47], 0
    v_mfma_f32_16x16x32_bf16 v[12:15], a[68:71], v[48:51], v[12:15]
    v_mfma_f32_16x16x32_bf16 v[12:15], a[72:75], v[52:55], v[12:15]
    v_mfma_f32_16x16x32_bf16 v[12:15], a[76:79], v[56:59], v[12:15]
    s_nop 7
    v_mov_b32_dpp v12, v13 quad_perm:[0,1,2,3] row_mask:0xf bank_mask:0x2
    v_mov_b32_dpp v12, v14 quad_perm:[0,1,2,3] row_mask:0xf bank_mask:0x4
    v_mov_b32_dpp v12, v15 quad_perm:[0,1,2,3] row_mask:0xf bank_mask:0x8
    s_nop 1
    v_add_f32_dpp v12, v12, v12 row_ror:4 row_mask:0xf bank_mask:0xf
    s_nop 1
    v_add_f32_dpp v18, v12, v12 row_ror:8 row_mask:0xf bank_mask:0x1
    s_waitcnt vmcnt(48)
    v_mfma_f32_16x16x32_bf16 v[12:15], a[80:83], v[44:47], 0
    v_mfma_f32_16x16x32_bf16 v[12:15], a[84:87], v[48:51], v[12:15]
    v_mfma_f32_16x16x32_bf16 v[12:15], a[88:91], v[52:55], v[12:15]
    v_mfma_f32_16x16x32_bf16 v[12:15], a[92:95], v[56:59], v[12:15]
    s_nop 7
    v_mov_b32_dpp v12, v13 quad_perm:[0,1,2,3] row_mask:0xf bank_mask:0x2
    v_mov_b32_dpp v12, v14 quad_perm:[0,1,2,3] row_mask:0xf bank_mask:0x4
    v_mov_b32_dpp v12, v15 quad_perm:[0,1,2,3] row_mask:0xf bank_mask:0x8
    s_nop 1
    v_add_f32_dpp v12, v12, v12 row_ror:4 row_mask:0xf bank_mask:0xf
    s_nop 1
    v_add_f32_dpp v18, v12, v12 row_ror:8 row_mask:0xf bank_mask:0x2
    s_waitcnt vmcnt(44)
    v_mfma_f32_16x16x32_bf16 v[12:15], a[96:99], v[44:47], 0
    v_mfma_f32_16x16x32_bf16 v[12:15], a[100:103], v[48:51], v[12:15]
    v_mfma_f32_16x16x32_bf16 v[12:15], a[104:107], v[52:55], v[12:15]
    v_mfma_f32_16x16x32_bf16 v[12:15], a[108:111], v[56:59], v[12:15]
    s_xor_b32 s59, s78, 2131200
    v_xor_b32 v62, s59, v2
    buffer_load_dwordx4 v[224:227], v62, s[32:35], 0 offen nt
    s_xor_b32 s59, s78, 17408
    v_xor_b32 v62, s59, v2
    buffer_load_dwordx4 v[228:231], v62, s[32:35], 0 offen nt
    s_xor_b32 s59, s78, 2205440
    v_xor_b32 v62, s59, v2
    buffer_load_dwordx4 v[232:235], v62, s[32:35], 0 offen nt
    s_xor_b32 s59, s78, 91648
    v_xor_b32 v62, s59, v2
    buffer_load_dwordx4 v[236:239], v62, s[32:35], 0 offen nt
    v_mov_b32_dpp v12, v13 quad_perm:[0,1,2,3] row_mask:0xf bank_mask:0x2
    v_mov_b32_dpp v12, v14 quad_perm:[0,1,2,3] row_mask:0xf bank_mask:0x4
    v_mov_b32_dpp v12, v15 quad_perm:[0,1,2,3] row_mask:0xf bank_mask:0x8
    s_nop 1
    v_add_f32_dpp v12, v12, v12 row_ror:4 row_mask:0xf bank_mask:0xf
    s_nop 1
    v_add_f32_dpp v18, v12, v12 row_ror:8 row_mask:0xf bank_mask:0x4
    s_waitcnt vmcnt(44)
    v_mfma_f32_16x16x32_bf16 v[12:15], a[112:115], v[44:47], 0
    v_mfma_f32_16x16x32_bf16 v[12:15], a[116:119], v[48:51], v[12:15]
    v_mfma_f32_16x16x32_bf16 v[12:15], a[120:123], v[52:55], v[12:15]
    v_mfma_f32_16x16x32_bf16 v[12:15], a[124:127], v[56:59], v[12:15]
    s_nop 7
    v_mov_b32_dpp v12, v13 quad_perm:[0,1,2,3] row_mask:0xf bank_mask:0x2
    v_mov_b32_dpp v12, v14 quad_perm:[0,1,2,3] row_mask:0xf bank_mask:0x4
    v_mov_b32_dpp v12, v15 quad_perm:[0,1,2,3] row_mask:0xf bank_mask:0x8
    s_nop 1
    v_add_f32_dpp v12, v12, v12 row_ror:4 row_mask:0xf bank_mask:0xf
    s_nop 1
    v_add_f32_dpp v18, v12, v12 row_ror:8 row_mask:0xf bank_mask:0x8
    v_cvt_pk_bf16_f32 v16, v18, v18
    v_and_b32 v16, s56, v16
    v_mul_f32 v16, s30, v16
    v_cvt_pk_bf16_f32 v16, v16, v16
    v_and_b32 v16, s56, v16
    v_max_f32 v19, v19, v16
    ds_write_b32 v26, v16 offset:5632
    v_add_u32 v26, 0x100, v26
    s_waitcnt vmcnt(40)
    v_mfma_f32_16x16x32_bf16 v[12:15], a[128:131], v[44:47], 0
    v_mfma_f32_16x16x32_bf16 v[12:15], a[132:135], v[48:51], v[12:15]
    v_mfma_f32_16x16x32_bf16 v[12:15], a[136:139], v[52:55], v[12:15]
    v_mfma_f32_16x16x32_bf16 v[12:15], a[140:143], v[56:59], v[12:15]
    s_xor_b32 s59, s78, 2188800
    v_xor_b32 v62, s59, v2
    buffer_load_dwordx4 v[240:243], v62, s[32:35], 0 offen nt
    s_xor_b32 s59, s78, 108288
    v_xor_b32 v62, s59, v2
    buffer_load_dwordx4 v[244:247], v62, s[32:35], 0 offen nt
    s_xor_b32 s59, s78, 2114560
    v_xor_b32 v62, s59, v2
    buffer_load_dwordx4 v[248:251], v62, s[32:35], 0 offen nt
    s_xor_b32 s59, s78, 34048
    v_xor_b32 v62, s59, v2
    buffer_load_dwordx4 v[252:255], v62, s[32:35], 0 offen nt
    v_mov_b32_dpp v12, v13 quad_perm:[0,1,2,3] row_mask:0xf bank_mask:0x2
    v_mov_b32_dpp v12, v14 quad_perm:[0,1,2,3] row_mask:0xf bank_mask:0x4
    v_mov_b32_dpp v12, v15 quad_perm:[0,1,2,3] row_mask:0xf bank_mask:0x8
    s_nop 1
    v_add_f32_dpp v12, v12, v12 row_ror:4 row_mask:0xf bank_mask:0xf
    s_nop 1
    v_add_f32_dpp v18, v12, v12 row_ror:8 row_mask:0xf bank_mask:0x1
    s_waitcnt vmcnt(40)
    v_mfma_f32_16x16x32_bf16 v[12:15], a[144:147], v[44:47], 0
    v_mfma_f32_16x16x32_bf16 v[12:15], a[148:151], v[48:51], v[12:15]
    v_mfma_f32_16x16x32_bf16 v[12:15], a[152:155], v[52:55], v[12:15]
    v_mfma_f32_16x16x32_bf16 v[12:15], a[156:159], v[56:59], v[12:15]
    s_nop 7
    v_mov_b32_dpp v12, v13 quad_perm:[0,1,2,3] row_mask:0xf bank_mask:0x2
    v_mov_b32_dpp v12, v14 quad_perm:[0,1,2,3] row_mask:0xf bank_mask:0x4
    v_mov_b32_dpp v12, v15 quad_perm:[0,1,2,3] row_mask:0xf bank_mask:0x8
    s_nop 1
    v_add_f32_dpp v12, v12, v12 row_ror:4 row_mask:0xf bank_mask:0xf
    s_nop 1
    v_add_f32_dpp v18, v12, v12 row_ror:8 row_mask:0xf bank_mask:0x2
    s_waitcnt vmcnt(36)
    v_mfma_f32_16x16x32_bf16 v[12:15], a[160:163], v[44:47], 0
    v_mfma_f32_16x16x32_bf16 v[12:15], a[164:167], v[48:51], v[12:15]
    v_mfma_f32_16x16x32_bf16 v[12:15], a[168:171], v[52:55], v[12:15]
    v_mfma_f32_16x16x32_bf16 v[12:15], a[172:175], v[56:59], v[12:15]
    s_xor_b32 s59, s78, 541696
    v_xor_b32 v62, s59, v2
    buffer_load_dwordx4 v[64:67], v62, s[32:35], 0 offen nt
    s_xor_b32 s59, s78, 2655488
    v_xor_b32 v62, s59, v2
    buffer_load_dwordx4 v[68:71], v62, s[32:35], 0 offen nt
    s_xor_b32 s59, s78, 615936
    v_xor_b32 v62, s59, v2
    buffer_load_dwordx4 v[72:75], v62, s[32:35], 0 offen nt
    s_xor_b32 s59, s78, 2729728
    v_xor_b32 v62, s59, v2
    buffer_load_dwordx4 v[76:79], v62, s[32:35], 0 offen nt
    v_mov_b32_dpp v12, v13 quad_perm:[0,1,2,3] row_mask:0xf bank_mask:0x2
    v_mov_b32_dpp v12, v14 quad_perm:[0,1,2,3] row_mask:0xf bank_mask:0x4
    v_mov_b32_dpp v12, v15 quad_perm:[0,1,2,3] row_mask:0xf bank_mask:0x8
    s_nop 1
    v_add_f32_dpp v12, v12, v12 row_ror:4 row_mask:0xf bank_mask:0xf
    s_nop 1
    v_add_f32_dpp v18, v12, v12 row_ror:8 row_mask:0xf bank_mask:0x4
    s_waitcnt vmcnt(36)
    v_mfma_f32_16x16x32_bf16 v[12:15], a[176:179], v[44:47], 0
    v_mfma_f32_16x16x32_bf16 v[12:15], a[180:183], v[48:51], v[12:15]
    v_mfma_f32_16x16x32_bf16 v[12:15], a[184:187], v[52:55], v[12:15]
    v_mfma_f32_16x16x32_bf16 v[12:15], a[188:191], v[56:59], v[12:15]
    s_nop 7
    v_mov_b32_dpp v12, v13 quad_perm:[0,1,2,3] row_mask:0xf bank_mask:0x2
    v_mov_b32_dpp v12, v14 quad_perm:[0,1,2,3] row_mask:0xf bank_mask:0x4
    v_mov_b32_dpp v12, v15 quad_perm:[0,1,2,3] row_mask:0xf bank_mask:0x8
    s_nop 1
    v_add_f32_dpp v12, v12, v12 row_ror:4 row_mask:0xf bank_mask:0xf
    s_nop 1
    v_add_f32_dpp v18, v12, v12 row_ror:8 row_mask:0xf bank_mask:0x8
    v_cvt_pk_bf16_f32 v16, v18, v18
    v_and_b32 v16, s56, v16
    v_mul_f32 v16, s30, v16
    v_cvt_pk_bf16_f32 v16, v16, v16
    v_and_b32 v16, s56, v16
    v_max_f32 v19, v19, v16
    ds_write_b32 v26, v16 offset:5632
    v_add_u32 v26, 0x100, v26
    s_waitcnt vmcnt(32)
    v_mfma_f32_16x16x32_bf16 v[12:15], v[128:131], v[44:47], 0
    v_mfma_f32_16x16x32_bf16 v[12:15], v[132:135], v[48:51], v[12:15]
    v_mfma_f32_16x16x32_bf16 v[12:15], v[136:139], v[52:55], v[12:15]
    v_mfma_f32_16x16x32_bf16 v[12:15], v[140:143], v[56:59], v[12:15]
    s_nop 7
    v_mov_b32_dpp v12, v13 quad_perm:[0,1,2,3] row_mask:0xf bank_mask:0x2
    v_mov_b32_dpp v12, v14 quad_perm:[0,1,2,3] row_mask:0xf bank_mask:0x4
    v_mov_b32_dpp v12, v15 quad_perm:[0,1,2,3] row_mask:0xf bank_mask:0x8
    s_nop 1
    v_add_f32_dpp v12, v12, v12 row_ror:4 row_mask:0xf bank_mask:0xf
    s_nop 1
    v_add_f32_dpp v18, v12, v12 row_ror:8 row_mask:0xf bank_mask:0x1
    s_waitcnt vmcnt(28)
    v_mfma_f32_16x16x32_bf16 v[12:15], v[144:147], v[44:47], 0
    v_mfma_f32_16x16x32_bf16 v[12:15], v[148:151], v[48:51], v[12:15]
    v_mfma_f32_16x16x32_bf16 v[12:15], v[152:155], v[52:55], v[12:15]
    v_mfma_f32_16x16x32_bf16 v[12:15], v[156:159], v[56:59], v[12:15]
    s_xor_b32 s59, s78, 632576
    v_xor_b32 v62, s59, v2
    buffer_load_dwordx4 v[80:83], v62, s[32:35], 0 offen nt
    s_xor_b32 s59, s78, 2713088
    v_xor_b32 v62, s59, v2
    buffer_load_dwordx4 v[84:87], v62, s[32:35], 0 offen nt
    s_xor_b32 s59, s78, 558336
    v_xor_b32 v62, s59, v2
    buffer_load_dwordx4 v[88:91], v62, s[32:35], 0 offen nt
    s_xor_b32 s59, s78, 2638848
    v_xor_b32 v62, s59, v2
    buffer_load_dwordx4 v[92:95], v62, s[32:35], 0 offen nt
    v_mov_b32_dpp v12, v13 quad_perm:[0,1,2,3] row_mask:0xf bank_mask:0x2
    v_mov_b32_dpp v12, v14 quad_perm:[0,1,2,3] row_mask:0xf bank_mask:0x4
    v_mov_b32_dpp v12, v15 quad_perm:[0,1,2,3] row_mask:0xf bank_mask:0x8
    s_nop 1
    v_add_f32_dpp v12, v12, v12 row_ror:4 row_mask:0xf bank_mask:0xf
    s_nop 1
    v_add_f32_dpp v18, v12, v12 row_ror:8 row_mask:0xf bank_mask:0x2
    s_waitcnt vmcnt(28)
    v_mfma_f32_16x16x32_bf16 v[12:15], v[160:163], v[44:47], 0
    v_mfma_f32_16x16x32_bf16 v[12:15], v[164:167], v[48:51], v[12:15]
    v_mfma_f32_16x16x32_bf16 v[12:15], v[168:171], v[52:55], v[12:15]
    v_mfma_f32_16x16x32_bf16 v[12:15], v[172:175], v[56:59], v[12:15]
    s_nop 7
    v_mov_b32_dpp v12, v13 quad_perm:[0,1,2,3] row_mask:0xf bank_mask:0x2
    v_mov_b32_dpp v12, v14 quad_perm:[0,1,2,3] row_mask:0xf bank_mask:0x4
    v_mov_b32_dpp v12, v15 quad_perm:[0,1,2,3] row_mask:0xf bank_mask:0x8
    s_nop 1
    v_add_f32_dpp v12, v12, v12 row_ror:4 row_mask:0xf bank_mask:0xf
    s_nop 1
    v_add_f32_dpp v18, v12, v12 row_ror:8 row_mask:0xf bank_mask:0x4
    s_waitcnt vmcnt(24)
    v_mfma_f32_16x16x32_bf16 v[12:15], v[176:179], v[44:47], 0
    v_mfma_f32_16x16x32_bf16 v[12:15], v[180:183], v[48:51], v[12:15]
    v_mfma_f32_16x16x32_bf16 v[12:15], v[184:187], v[52:55], v[12:15]
    v_mfma_f32_16x16x32_bf16 v[12:15], v[188:191], v[56:59], v[12:15]
    s_xor_b32 s59, s78, 13637120
    v_xor_b32 v62, s59, v2
    buffer_load_dwordx4 v[96:99], v62, s[32:35], 0 offen nt
    s_xor_b32 s59, s78, 15783680
    v_xor_b32 v62, s59, v2
    buffer_load_dwordx4 v[100:103], v62, s[32:35], 0 offen nt
    s_xor_b32 s59, s78, 13710336
    v_xor_b32 v62, s59, v2
    buffer_load_dwordx4 v[104:107], v62, s[32:35], 0 offen nt
    s_xor_b32 s59, s78, 15856896
    v_xor_b32 v62, s59, v2
    buffer_load_dwordx4 v[108:111], v62, s[32:35], 0 offen nt
    v_mov_b32_dpp v12, v13 quad_perm:[0,1,2,3] row_mask:0xf bank_mask:0x2
    v_mov_b32_dpp v12, v14 quad_perm:[0,1,2,3] row_mask:0xf bank_mask:0x4
    v_mov_b32_dpp v12, v15 quad_perm:[0,1,2,3] row_mask:0xf bank_mask:0x8
    s_nop 1
    v_add_f32_dpp v12, v12, v12 row_ror:4 row_mask:0xf bank_mask:0xf
    s_nop 1
    v_add_f32_dpp v18, v12, v12 row_ror:8 row_mask:0xf bank_mask:0x8
    v_cvt_pk_bf16_f32 v16, v18, v18
    v_and_b32 v16, s56, v16
    v_mul_f32 v16, s30, v16
    v_cvt_pk_bf16_f32 v16, v16, v16
    v_and_b32 v16, s56, v16
    v_max_f32 v19, v19, v16
    ds_write_b32 v26, v16 offset:5632
    v_add_u32 v26, 0x100, v26
    s_waitcnt vmcnt(24)
    v_mfma_f32_16x16x32_bf16 v[12:15], v[192:195], v[44:47], 0
    v_mfma_f32_16x16x32_bf16 v[12:15], v[196:199], v[48:51], v[12:15]
    v_mfma_f32_16x16x32_bf16 v[12:15], v[200:203], v[52:55], v[12:15]
    v_mfma_f32_16x16x32_bf16 v[12:15], v[204:207], v[56:59], v[12:15]
    s_nop 7
    v_mov_b32_dpp v12, v13 quad_perm:[0,1,2,3] row_mask:0xf bank_mask:0x2
    v_mov_b32_dpp v12, v14 quad_perm:[0,1,2,3] row_mask:0xf bank_mask:0x4
    v_mov_b32_dpp v12, v15 quad_perm:[0,1,2,3] row_mask:0xf bank_mask:0x8
    s_nop 1
    v_add_f32_dpp v12, v12, v12 row_ror:4 row_mask:0xf bank_mask:0xf
    s_nop 1
    v_add_f32_dpp v18, v12, v12 row_ror:8 row_mask:0xf bank_mask:0x1
    s_waitcnt vmcnt(20)
    v_mfma_f32_16x16x32_bf16 v[12:15], v[208:211], v[44:47], 0
    v_mfma_f32_16x16x32_bf16 v[12:15], v[212:215], v[48:51], v[12:15]
    v_mfma_f32_16x16x32_bf16 v[12:15], v[216:219], v[52:55], v[12:15]
    v_mfma_f32_16x16x32_bf16 v[12:15], v[220:223], v[56:59], v[12:15]
    s_xor_b32 s59, s78, 13759744
    v_xor_b32 v62, s59, v2
    buffer_load_dwordx4 v[112:115], v62, s[32:35], 0 offen nt
    s_xor_b32 s59, s78, 15807488
    v_xor_b32 v62, s59, v2
    buffer_load_dwordx4 v[116:119], v62, s[32:35], 0 offen nt
    s_xor_b32 s59, s78, 13686528
    v_xor_b32 v62, s59, v2
    buffer_load_dwordx4 v[120:123], v62, s[32:35], 0 offen nt
    s_xor_b32 s59, s78, 15734272
    v_xor_b32 v62, s59, v2
    buffer_load_dwordx4 v[124:127], v62, s[32:35], 0 offen nt
    v_mov_b32_dpp v12, v13 quad_perm:[0,1,2,3] row_mask:0xf bank_mask:0x2
    v_mov_b32_dpp v12, v14 quad_perm:[0,1,2,3] row_mask:0xf bank_mask:0x4
    v_mov_b32_dpp v12, v15 quad_perm:[0,1,2,3] row_mask:0xf bank_mask:0x8
    s_nop 1
    v_add_f32_dpp v12, v12, v12 row_ror:4 row_mask:0xf bank_mask:0xf
    s_nop 1
    v_add_f32_dpp v18, v12, v12 row_ror:8 row_mask:0xf bank_mask:0x2
    s_waitcnt vmcnt(20)
    v_mfma_f32_16x16x32_bf16 v[12:15], v[224:227], v[44:47], 0
    v_mfma_f32_16x16x32_bf16 v[12:15], v[228:231], v[48:51], v[12:15]
    v_mfma_f32_16x16x32_bf16 v[12:15], v[232:235], v[52:55], v[12:15]
    v_mfma_f32_16x16x32_bf16 v[12:15], v[236:239], v[56:59], v[12:15]
    s_nop 7
    v_mov_b32_dpp v12, v13 quad_perm:[0,1,2,3] row_mask:0xf bank_mask:0x2
    v_mov_b32_dpp v12, v14 quad_perm:[0,1,2,3] row_mask:0xf bank_mask:0x4
    v_mov_b32_dpp v12, v15 quad_perm:[0,1,2,3] row_mask:0xf bank_mask:0x8
    s_nop 1
    v_add_f32_dpp v12, v12, v12 row_ror:4 row_mask:0xf bank_mask:0xf
    s_nop 1
    v_add_f32_dpp v18, v12, v12 row_ror:8 row_mask:0xf bank_mask:0x4
    s_waitcnt vmcnt(16)
    v_mfma_f32_16x16x32_bf16 v[12:15], v[240:243], v[44:47], 0
    v_mfma_f32_16x16x32_bf16 v[12:15], v[244:247], v[48:51], v[12:15]
    v_mfma_f32_16x16x32_bf16 v[12:15], v[248:251], v[52:55], v[12:15]
    v_mfma_f32_16x16x32_bf16 v[12:15], v[252:255], v[56:59], v[12:15]
    s_nop 7
    v_mov_b32_dpp v12, v13 quad_perm:[0,1,2,3] row_mask:0xf bank_mask:0x2
    v_mov_b32_dpp v12, v14 quad_perm:[0,1,2,3] row_mask:0xf bank_mask:0x4
    v_mov_b32_dpp v12, v15 quad_perm:[0,1,2,3] row_mask:0xf bank_mask:0x8
    s_nop 1
    v_add_f32_dpp v12, v12, v12 row_ror:4 row_mask:0xf bank_mask:0xf
    s_nop 1
    v_add_f32_dpp v18, v12, v12 row_ror:8 row_mask:0xf bank_mask:0x8
    v_cvt_pk_bf16_f32 v16, v18, v18
    v_and_b32 v16, s56, v16
    v_mul_f32 v16, s30, v16
    v_cvt_pk_bf16_f32 v16, v16, v16
    v_and_b32 v16, s56, v16
    v_max_f32 v19, v19, v16
    ds_write_b32 v26, v16 offset:5632
    v_add_u32 v26, 0x100, v26
    s_xor_b32 s65, s78, 541696
    s_mov_b32 s72, 8
L_kloop_parallel_sum__mha_block_:
    s_mov_b32 s64, s65
    s_add_u32 s72, s72, 1
    v_readlane_b32 s65, v61, s72
    s_xor_b32 s65, s65, s78
    s_waitcnt vmcnt(12)
    v_mfma_f32_16x16x32_bf16 v[12:15], v[64:67], v[44:47], 0
    v_mfma_f32_16x16x32_bf16 v[12:15], v[68:71], v[48:51], v[12:15]
    v_mfma_f32_16x16x32_bf16 v[12:15], v[72:75], v[52:55], v[12:15]
    v_mfma_f32_16x16x32_bf16 v[12:15], v[76:79], v[56:59], v[12:15]
    v_xor_b32 v62, s65, v2
    s_waitcnt vmcnt(9)
    buffer_load_dwordx4 v[64:67], v62, s[32:35], 0 offen nt
    s_xor_b32 s59, s65, 2146560
    v_xor_b32 v62, s59, v2
    s_waitcnt vmcnt(9)
    buffer_load_dwordx4 v[68:71], v62, s[32:35], 0 offen nt
    s_xor_b32 s59, s65, 74240
    v_xor_b32 v62, s59, v2
    s_waitcnt vmcnt(9)
    buffer_load_dwordx4 v[72:75], v62, s[32:35], 0 offen nt
    s_xor_b32 s59, s65, 2220800
    v_xor_b32 v62, s59, v2
    s_waitcnt vmcnt(9)
    buffer_load_dwordx4 v[76:79], v62, s[32:35], 0 offen nt
    v_mov_b32_dpp v12, v13 quad_perm:[0,1,2,3] row_mask:0xf bank_mask:0x2
    v_mov_b32_dpp v12, v14 quad_perm:[0,1,2,3] row_mask:0xf bank_mask:0x4
    v_mov_b32_dpp v12, v15 quad_perm:[0,1,2,3] row_mask:0xf bank_mask:0x8
    s_nop 1
    v_add_f32_dpp v12, v12, v12 row_ror:4 row_mask:0xf bank_mask:0xf
    s_nop 1
    v_add_f32_dpp v18, v12, v12 row_ror:8 row_mask:0xf bank_mask:0x1
    s_waitcnt vmcnt(12)
    v_mfma_f32_16x16x32_bf16 v[12:15], v[80:83], v[44:47], 0
    v_mfma_f32_16x16x32_bf16 v[12:15], v[84:87], v[48:51], v[12:15]
    v_mfma_f32_16x16x32_bf16 v[12:15], v[88:91], v[52:55], v[12:15]
    v_mfma_f32_16x16x32_bf16 v[12:15], v[92:95], v[56:59], v[12:15]
    s_xor_b32 s59, s65, 123648
    v_xor_b32 v62, s59, v2
    s_waitcnt vmcnt(9)
    buffer_load_dwordx4 v[80:83], v62, s[32:35], 0 offen nt
    s_xor_b32 s59, s65, 2171392
    v_xor_b32 v62, s59, v2
    s_waitcnt vmcnt(9)
    buffer_load_dwordx4 v[84:87], v62, s[32:35], 0 offen nt
    s_xor_b32 s59, s65, 49408
    v_xor_b32 v62, s59, v2
    s_waitcnt vmcnt(9)
    buffer_load_dwordx4 v[88:91], v62, s[32:35], 0 offen nt
    s_xor_b32 s59, s65, 2097152
    v_xor_b32 v62, s59, v2
    s_waitcnt vmcnt(9)
    buffer_load_dwordx4 v[92:95], v62, s[32:35], 0 offen nt
    v_mov_b32_dpp v12, v13 quad_perm:[0,1,2,3] row_mask:0xf bank_mask:0x2
    v_mov_b32_dpp v12, v14 quad_perm:[0,1,2,3] row_mask:0xf bank_mask:0x4
    v_mov_b32_dpp v12, v15 quad_perm:[0,1,2,3] row_mask:0xf bank_mask:0x8
    s_nop 1
    v_add_f32_dpp v12, v12, v12 row_ror:4 row_mask:0xf bank_mask:0xf
    s_nop 1
    v_add_f32_dpp v18, v12, v12 row_ror:8 row_mask:0xf bank_mask:0x2
    s_waitcnt vmcnt(12)
    v_mfma_f32_16x16x32_bf16 v[12:15], v[96:99], v[44:47], 0
    v_mfma_f32_16x16x32_bf16 v[12:15], v[100:103], v[48:51], v[12:15]
    v_mfma_f32_16x16x32_bf16 v[12:15], v[104:107], v[52:55], v[12:15]
    v_mfma_f32_16x16x32_bf16 v[12:15], v[108:111], v[56:59], v[12:15]
    s_xor_b32 s59, s65, 14176768
    v_xor_b32 v62, s59, v2
    s_waitcnt vmcnt(9)
    buffer_load_dwordx4 v[96:99], v62, s[32:35], 0 offen nt
    s_xor_b32 s59, s65, 16290560
    v_xor_b32 v62, s59, v2
    s_waitcnt vmcnt(9)
    buffer_load_dwordx4 v[100:103], v62, s[32:35], 0 offen nt
    s_xor_b32 s59, s65, 14249984
    v_xor_b32 v62, s59, v2
    s_waitcnt vmcnt(9)
    buffer_load_dwordx4 v[104:107], v62, s[32:35], 0 offen nt
    s_xor_b32 s59, s65, 16363776
    v_xor_b32 v62, s59, v2
    s_waitcnt vmcnt(9)
    buffer_load_dwordx4 v[108:111], v62, s[32:35], 0 offen nt
    v_mov_b32_dpp v12, v13 quad_perm:[0,1,2,3] row_mask:0xf bank_mask:0x2
    v_mov_b32_dpp v12, v14 quad_perm:[0,1,2,3] row_mask:0xf bank_mask:0x4
    v_mov_b32_dpp v12, v15 quad_perm:[0,1,2,3] row_mask:0xf bank_mask:0x8
    s_nop 1
    v_add_f32_dpp v12, v12, v12 row_ror:4 row_mask:0xf bank_mask:0xf
    s_nop 1
    v_add_f32_dpp v18, v12, v12 row_ror:8 row_mask:0xf bank_mask:0x4
    s_waitcnt vmcnt(12)
    v_mfma_f32_16x16x32_bf16 v[12:15], v[112:115], v[44:47], 0
    v_mfma_f32_16x16x32_bf16 v[12:15], v[116:119], v[48:51], v[12:15]
    v_mfma_f32_16x16x32_bf16 v[12:15], v[120:123], v[52:55], v[12:15]
    v_mfma_f32_16x16x32_bf16 v[12:15], v[124:127], v[56:59], v[12:15]
    s_xor_b32 s59, s65, 14266624
    v_xor_b32 v62, s59, v2
    s_waitcnt vmcnt(9)
    buffer_load_dwordx4 v[112:115], v62, s[32:35], 0 offen nt
    s_xor_b32 s59, s65, 16347136
    v_xor_b32 v62, s59, v2
    s_waitcnt vmcnt(9)
    buffer_load_dwordx4 v[116:119], v62, s[32:35], 0 offen nt
    s_xor_b32 s59, s65, 14193408
    v_xor_b32 v62, s59, v2
    s_waitcnt vmcnt(9)
    buffer_load_dwordx4 v[120:123], v62, s[32:35], 0 offen nt
    s_xor_b32 s59, s65, 16273920
    v_xor_b32 v62, s59, v2
    s_waitcnt vmcnt(9)
    buffer_load_dwordx4 v[124:127], v62, s[32:35], 0 offen nt
    v_mov_b32_dpp v12, v13 quad_perm:[0,1,2,3] row_mask:0xf bank_mask:0x2
    v_mov_b32_dpp v12, v14 quad_perm:[0,1,2,3] row_mask:0xf bank_mask:0x4
    v_mov_b32_dpp v12, v15 quad_perm:[0,1,2,3] row_mask:0xf bank_mask:0x8
    s_nop 1
    v_add_f32_dpp v12, v12, v12 row_ror:4 row_mask:0xf bank_mask:0xf
    s_nop 1
    v_add_f32_dpp v18, v12, v12 row_ror:8 row_mask:0xf bank_mask:0x8
    v_cvt_pk_bf16_f32 v16, v18, v18
    v_and_b32 v16, s56, v16
    v_mul_f32 v16, s30, v16
    v_cvt_pk_bf16_f32 v16, v16, v16
    v_and_b32 v16, s56, v16
    v_max_f32 v19, v19, v16
    ds_write_b32 v26, v16 offset:5632
    v_add_u32 v26, 0x100, v26
    s_cmp_lt_u32 s72, 57
    s_cbranch_scc1 L_kloop_parallel_sum__mha_block_
L_kloopt_parallel_sum__mha_block_:
    s_mov_b32 s64, s65
    s_add_u32 s72, s72, 1
    v_readlane_b32 s65, v61, s72
    s_xor_b32 s65, s65, s78
    s_waitcnt vmcnt(12)
    v_mfma_f32_16x16x32_bf16 v[12:15], v[64:67], v[44:47], 0
    v_mfma_f32_16x16x32_bf16 v[12:15], v[68:71], v[48:51], v[12:15]
    v_mfma_f32_16x16x32_bf16 v[12:15], v[72:75], v[52:55], v[12:15]
    v_mfma_f32_16x16x32_bf16 v[12:15], v[76:79], v[56:59], v[12:15]
    v_xor_b32 v62, s65, v2
    buffer_load_dwordx4 v[64:67], v62, s[32:35], 0 offen nt
    s_xor_b32 s59, s65, 2146560
    v_xor_b32 v62, s59, v2
    buffer_load_dwordx4 v[68:71], v62, s[32:35], 0 offen nt
    s_xor_b32 s59, s65, 74240
    v_xor_b32 v62, s59, v2
    buffer_load_dwordx4 v[72:75], v62, s[32:35], 0 offen nt
    s_xor_b32 s59, s65, 2220800
    v_xor_b32 v62, s59, v2
    buffer_load_dwordx4 v[76:79], v62, s[32:35], 0 offen nt
    v_mov_b32_dpp v12, v13 quad_perm:[0,1,2,3] row_mask:0xf bank_mask:0x2
    v_mov_b32_dpp v12, v14 quad_perm:[0,1,2,3] row_mask:0xf bank_mask:0x4
    v_mov_b32_dpp v12, v15 quad_perm:[0,1,2,3] row_mask:0xf bank_mask:0x8
    s_nop 1
    v_add_f32_dpp v12, v12, v12 row_ror:4 row_mask:0xf bank_mask:0xf
    s_nop 1
    v_add_f32_dpp v18, v12, v12 row_ror:8 row_mask:0xf bank_mask:0x1
    s_waitcnt vmcnt(12)
    v_mfma_f32_16x16x32_bf16 v[12:15], v[80:83], v[44:47], 0
    v_mfma_f32_16x16x32_bf16 v[12:15], v[84:87], v[48:51], v[12:15]
    v_mfma_f32_16x16x32_bf16 v[12:15], v[88:91], v[52:55], v[12:15]
    v_mfma_f32_16x16x32_bf16 v[12:15], v[92:95], v[56:59], v[12:15]
    s_xor_b32 s59, s65, 123648
    v_xor_b32 v62, s59, v2
    buffer_load_dwordx4 v[80:83], v62, s[32:35], 0 offen nt
    s_xor_b32 s59, s65, 2171392
    v_xor_b32 v62, s59, v2
    buffer_load_dwordx4 v[84:87], v62, s[32:35], 0 offen nt
    s_xor_b32 s59, s65, 49408
    v_xor_b32 v62, s59, v2
    buffer_load_dwordx4 v[88:91], v62, s[32:35], 0 offen nt
    s_xor_b32 s59, s65, 2097152
    v_xor_b32 v62, s59, v2
    buffer_load_dwordx4 v[92:95], v62, s[32:35], 0 offen nt
    v_mov_b32_dpp v12, v13 quad_perm:[0,1,2,3] row_mask:0xf bank_mask:0x2
    v_mov_b32_dpp v12, v14 quad_perm:[0,1,2,3] row_mask:0xf bank_mask:0x4
    v_mov_b32_dpp v12, v15 quad_perm:[0,1,2,3] row_mask:0xf bank_mask:0x8
    s_nop 1
    v_add_f32_dpp v12, v12, v12 row_ror:4 row_mask:0xf bank_mask:0xf
    s_nop 1
    v_add_f32_dpp v18, v12, v12 row_ror:8 row_mask:0xf bank_mask:0x2
    s_waitcnt vmcnt(12)
    v_mfma_f32_16x16x32_bf16 v[12:15], v[96:99], v[44:47], 0
    v_mfma_f32_16x16x32_bf16 v[12:15], v[100:103], v[48:51], v[12:15]
    v_mfma_f32_16x16x32_bf16 v[12:15], v[104:107], v[52:55], v[12:15]
    v_mfma_f32_16x16x32_bf16 v[12:15], v[108:111], v[56:59], v[12:15]
    s_xor_b32 s59, s65, 14176768
    v_xor_b32 v62, s59, v2
    buffer_load_dwordx4 v[96:99], v62, s[32:35], 0 offen nt
    s_xor_b32 s59, s65, 16290560
    v_xor_b32 v62, s59, v2
    buffer_load_dwordx4 v[100:103], v62, s[32:35], 0 offen nt
    s_xor_b32 s59, s65, 14249984
    v_xor_b32 v62, s59, v2
    buffer_load_dwordx4 v[104:107], v62, s[32:35], 0 offen nt
    s_xor_b32 s59, s65, 16363776
    v_xor_b32 v62, s59, v2
    buffer_load_dwordx4 v[108:111], v62, s[32:35], 0 offen nt
    v_mov_b32_dpp v12, v13 quad_perm:[0,1,2,3] row_mask:0xf bank_mask:0x2
    v_mov_b32_dpp v12, v14 quad_perm:[0,1,2,3] row_mask:0xf bank_mask:0x4
    v_mov_b32_dpp v12, v15 quad_perm:[0,1,2,3] row_mask:0xf bank_mask:0x8
    s_nop 1
    v_add_f32_dpp v12, v12, v12 row_ror:4 row_mask:0xf bank_mask:0xf
    s_nop 1
    v_add_f32_dpp v18, v12, v12 row_ror:8 row_mask:0xf bank_mask:0x4
    s_waitcnt vmcnt(12)
    v_mfma_f32_16x16x32_bf16 v[12:15], v[112:115], v[44:47], 0
    v_mfma_f32_16x16x32_bf16 v[12:15], v[116:119], v[48:51], v[12:15]
    v_mfma_f32_16x16x32_bf16 v[12:15], v[120:123], v[52:55], v[12:15]
    v_mfma_f32_16x16x32_bf16 v[12:15], v[124:127], v[56:59], v[12:15]
    s_xor_b32 s59, s65, 14266624
    v_xor_b32 v62, s59, v2
    buffer_load_dwordx4 v[112:115], v62, s[32:35], 0 offen nt
    s_xor_b32 s59, s65, 16347136
    v_xor_b32 v62, s59, v2
    buffer_load_dwordx4 v[116:119], v62, s[32:35], 0 offen nt
    s_xor_b32 s59, s65, 14193408
    v_xor_b32 v62, s59, v2
    buffer_load_dwordx4 v[120:123], v62, s[32:35], 0 offen nt
    s_xor_b32 s59, s65, 16273920
    v_xor_b32 v62, s59, v2
    buffer_load_dwordx4 v[124:127], v62, s[32:35], 0 offen nt
    v_mov_b32_dpp v12, v13 quad_perm:[0,1,2,3] row_mask:0xf bank_mask:0x2
    v_mov_b32_dpp v12, v14 quad_perm:[0,1,2,3] row_mask:0xf bank_mask:0x4
    v_mov_b32_dpp v12, v15 quad_perm:[0,1,2,3] row_mask:0xf bank_mask:0x8
    s_nop 1
    v_add_f32_dpp v12, v12, v12 row_ror:4 row_mask:0xf bank_mask:0xf
    s_nop 1
    v_add_f32_dpp v18, v12, v12 row_ror:8 row_mask:0xf bank_mask:0x8
    v_cvt_pk_bf16_f32 v16, v18, v18
    v_and_b32 v16, s56, v16
    v_mul_f32 v16, s30, v16
    v_cvt_pk_bf16_f32 v16, v16, v16
    v_and_b32 v16, s56, v16
    v_max_f32 v19, v19, v16
    ds_write_b32 v26, v16 offset:5632
    v_add_u32 v26, 0x100, v26
    s_cmp_lt_u32 s72, 60
    s_cbranch_scc1 L_kloopt_parallel_sum__mha_block_
    s_mov_b32 s64, s65
    ds_read_b32 v60, v27 offset:5632
    s_waitcnt vmcnt(12)
    v_mfma_f32_16x16x32_bf16 v[12:15], v[64:67], v[44:47], 0
    v_mfma_f32_16x16x32_bf16 v[12:15], v[68:71], v[48:51], v[12:15]
    v_mfma_f32_16x16x32_bf16 v[12:15], v[72:75], v[52:55], v[12:15]
    v_mfma_f32_16x16x32_bf16 v[12:15], v[76:79], v[56:59], v[12:15]
    v_xor_b32 v62, s78, v22
    s_waitcnt vmcnt(9)
    buffer_load_dwordx4 v[64:67], v62, s[36:39], 0 offen nt
    s_xor_b32 s59, s78, 2146560
    v_xor_b32 v62, s59, v22
    s_waitcnt vmcnt(9)
    buffer_load_dwordx4 v[68:71], v62, s[36:39], 0 offen nt
    s_xor_b32 s59, s78, 74240
    v_xor_b32 v62, s59, v22
    s_waitcnt vmcnt(9)
    buffer_load_dwordx4 v[72:75], v62, s[36:39], 0 offen nt
    s_xor_b32 s59, s78, 2220800
    v_xor_b32 v62, s59, v22
    s_waitcnt vmcnt(9)
    buffer_load_dwordx4 v[76:79], v62, s[36:39], 0 offen nt
    v_mov_b32_dpp v12, v13 quad_perm:[0,1,2,3] row_mask:0xf bank_mask:0x2
    v_mov_b32_dpp v12, v14 quad_perm:[0,1,2,3] row_mask:0xf bank_mask:0x4
    v_mov_b32_dpp v12, v15 quad_perm:[0,1,2,3] row_mask:0xf bank_mask:0x8
    s_nop 1
    v_add_f32_dpp v12, v12, v12 row_ror:4 row_mask:0xf bank_mask:0xf
    s_nop 1
    v_add_f32_dpp v18, v12, v12 row_ror:8 row_mask:0xf bank_mask:0x1
    s_waitcnt vmcnt(12)
    v_mfma_f32_16x16x32_bf16 v[12:15], v[80:83], v[44:47], 0
    v_mfma_f32_16x16x32_bf16 v[12:15], v[84:87], v[48:51], v[12:15]
    v_mfma_f32_16x16x32_bf16 v[12:15], v[88:91], v[52:55], v[12:15]
    v_mfma_f32_16x16x32_bf16 v[12:15], v[92:95], v[56:59], v[12:15]
    s_xor_b32 s59, s78, 123648
    v_xor_b32 v62, s59, v22
    s_waitcnt vmcnt(9)
    buffer_load_dwordx4 v[80:83], v62, s[36:39], 0 offen nt
    s_xor_b32 s59, s78, 2171392
    v_xor_b32 v62, s59, v22
    s_waitcnt vmcnt(9)
    buffer_load_dwordx4 v[84:87], v62, s[36:39], 0 offen nt
    s_xor_b32 s59, s78, 49408
    v_xor_b32 v62, s59, v22
    s_waitcnt vmcnt(9)
    buffer_load_dwordx4 v[88:91], v62, s[36:39], 0 offen nt
    s_xor_b32 s59, s78, 2097152
    v_xor_b32 v62, s59, v22
    s_waitcnt vmcnt(9)
    buffer_load_dwordx4 v[92:95], v62, s[36:39], 0 offen nt
    v_mov_b32_dpp v12, v13 quad_perm:[0,1,2,3] row_mask:0xf bank_mask:0x2
    v_mov_b32_dpp v12, v14 quad_perm:[0,1,2,3] row_mask:0xf bank_mask:0x4
    v_mov_b32_dpp v12, v15 quad_perm:[0,1,2,3] row_mask:0xf bank_mask:0x8
    s_nop 1
    v_add_f32_dpp v12, v12, v12 row_ror:4 row_mask:0xf bank_mask:0xf
    s_nop 1
    v_add_f32_dpp v18, v12, v12 row_ror:8 row_mask:0xf bank_mask:0x2
    s_waitcnt vmcnt(12)
    v_mfma_f32_16x16x32_bf16 v[12:15], v[96:99], v[44:47], 0
    v_mfma_f32_16x16x32_bf16 v[12:15], v[100:103], v[48:51], v[12:15]
    v_mfma_f32_16x16x32_bf16 v[12:15], v[104:107], v[52:55], v[12:15]
    v_mfma_f32_16x16x32_bf16 v[12:15], v[108:111], v[56:59], v[12:15]
    s_xor_b32 s59, s78, 14176768
    v_xor_b32 v62, s59, v22
    s_waitcnt vmcnt(9)
    buffer_load_dwordx4 v[96:99], v62, s[36:39], 0 offen nt
    s_xor_b32 s59, s78, 16290560
    v_xor_b32 v62, s59, v22
    s_waitcnt vmcnt(9)
    buffer_load_dwordx4 v[100:103], v62, s[36:39], 0 offen nt
    s_xor_b32 s59, s78, 14249984
    v_xor_b32 v62, s59, v22
    s_waitcnt vmcnt(9)
    buffer_load_dwordx4 v[104:107], v62, s[36:39], 0 offen nt
    s_xor_b32 s59, s78, 16363776
    v_xor_b32 v62, s59, v22
    s_waitcnt vmcnt(9)
    buffer_load_dwordx4 v[108:111], v62, s[36:39], 0 offen nt
    v_mov_b32_dpp v12, v13 quad_perm:[0,1,2,3] row_mask:0xf bank_mask:0x2
    v_mov_b32_dpp v12, v14 quad_perm:[0,1,2,3] row_mask:0xf bank_mask:0x4
    v_mov_b32_dpp v12, v15 quad_perm:[0,1,2,3] row_mask:0xf bank_mask:0x8
    s_nop 1
    v_add_f32_dpp v12, v12, v12 row_ror:4 row_mask:0xf bank_mask:0xf
    s_nop 1
    v_add_f32_dpp v18, v12, v12 row_ror:8 row_mask:0xf bank_mask:0x4
    s_waitcnt vmcnt(12)
    v_mfma_f32_16x16x32_bf16 v[12:15], v[112:115], v[44:47], 0
    v_mfma_f32_16x16x32_bf16 v[12:15], v[116:119], v[48:51], v[12:15]
    v_mfma_f32_16x16x32_bf16 v[12:15], v[120:123], v[52:55], v[12:15]
    v_mfma_f32_16x16x32_bf16 v[12:15], v[124:127], v[56:59], v[12:15]
    s_xor_b32 s59, s78, 14266624
    v_xor_b32 v62, s59, v22
    s_waitcnt vmcnt(9)
    buffer_load_dwordx4 v[112:115], v62, s[36:39], 0 offen nt
    s_xor_b32 s59, s78, 16347136
    v_xor_b32 v62, s59, v22
    s_waitcnt vmcnt(9)
    buffer_load_dwordx4 v[116:119], v62, s[36:39], 0 offen nt
    s_xor_b32 s59, s78, 14193408
    v_xor_b32 v62, s59, v22
    s_waitcnt vmcnt(9)
    buffer_load_dwordx4 v[120:123], v62, s[36:39], 0 offen nt
    s_xor_b32 s59, s78, 16273920
    v_xor_b32 v62, s59, v22
    s_waitcnt vmcnt(9)
    buffer_load_dwordx4 v[124:127], v62, s[36:39], 0 offen nt
    v_mov_b32_dpp v12, v13 quad_perm:[0,1,2,3] row_mask:0xf bank_mask:0x2
    v_mov_b32_dpp v12, v14 quad_perm:[0,1,2,3] row_mask:0xf bank_mask:0x4
    v_mov_b32_dpp v12, v15 quad_perm:[0,1,2,3] row_mask:0xf bank_mask:0x8
    s_nop 1
    v_add_f32_dpp v12, v12, v12 row_ror:4 row_mask:0xf bank_mask:0xf
    s_nop 1
    v_add_f32_dpp v18, v12, v12 row_ror:8 row_mask:0xf bank_mask:0x8
    v_cvt_pk_bf16_f32 v16, v18, v18
    v_and_b32 v16, s56, v16
    v_mul_f32 v16, s30, v16
    v_cvt_pk_bf16_f32 v16, v16, v16
    v_and_b32 v16, s56, v16
    v_max_f32 v19, v19, v16
    ds_write_b32 v26, v16 offset:5632
    v_add_u32 v26, 0x100, v26
    s_nop 1
    v_max_f32_dpp v19, v19, v19 quad_perm:[1,0,3,2] row_mask:0xf bank_mask:0xf
    s_nop 1
    v_max_f32_dpp v19, v19, v19 quad_perm:[2,3,0,1] row_mask:0xf bank_mask:0xf
    s_nop 1
    v_max_f32_dpp v19, v19, v19 row_half_mirror row_mask:0xf bank_mask:0xf
    s_nop 1
    v_max_f32_dpp v19, v19, v19 row_mirror row_mask:0xf bank_mask:0xf
    v_mov_b32 v16, v19
    s_nop 1
    v_permlane16_swap_b32 v19, v16
    s_nop 1
    v_max_f32 v19, v19, v16
    v_mov_b32 v16, v19
    s_nop 1
    v_permlane32_swap_b32 v19, v16
    s_nop 1
    v_max_f32 v19, v19, v16
    v_mul_f32 v20, s31, v19
    v_sub_f32 v20, 0, v20
    s_mov_b32 s65, s78
    s_mov_b32 s72, 0
L_vloop_parallel_sum__mha_block_:
    s_mov_b32 s64, s65
    s_add_u32 s72, s72, 1
    v_readlane_b32 s65, v61, s72
    s_xor_b32 s65, s65, s78
    s_waitcnt lgkmcnt(0)
    v_fma_f32 v16, v60, s31, v20
    v_add_u32 v27, 0x100, v27
    v_exp_f32 v16, v16
    ds_read_b32 v60, v27 offset:5632
    v_cvt_pk_bf16_f32 v17, v16, v16
    v_and_b32 v0, s56, v17
    v_sub_f32 v0, v16, v0
    v_cvt_pk_bf16_f32 v0, v0, v0
    v_add_f32 v21, v21, v16
    s_nop 0
    v_mov_b32_dpp v12, v17 row_newbcast:0 row_mask:0xf bank_mask:0x3
    v_mov_b32_dpp v13, v17 row_newbcast:1 row_mask:0xf bank_mask:0x3
    v_mov_b32_dpp v14, v17 row_newbcast:2 row_mask:0xf bank_mask:0x3
    v_mov_b32_dpp v15, v17 row_newbcast:3 row_mask:0xf bank_mask:0x3
    v_mov_b32_dpp v12, v0 row_newbcast:0 row_mask:0xf bank_mask:0xc
    v_mov_b32_dpp v13, v0 row_newbcast:1 row_mask:0xf bank_mask:0xc
    v_mov_b32_dpp v14, v0 row_newbcast:2 row_mask:0xf bank_mask:0xc
    v_mov_b32_dpp v15, v0 row_newbcast:3 row_mask:0xf bank_mask:0xc
    v_and_b32 v28, v12, v4
    v_and_b32 v29, v12, v5
    v_and_b32 v30, v12, v6
    v_and_b32 v31, v12, v7
    v_and_b32 v32, v13, v4
    v_and_b32 v33, v13, v5
    v_and_b32 v34, v13, v6
    v_and_b32 v35, v13, v7
    v_and_b32 v36, v14, v4
    v_and_b32 v37, v14, v5
    v_and_b32 v38, v14, v6
    v_and_b32 v39, v14, v7
    v_and_b32 v40, v15, v4
    v_and_b32 v41, v15, v5
    v_and_b32 v42, v15, v6
    v_and_b32 v43, v15, v7
    s_waitcnt vmcnt(12)
    s_nop 0
    v_mfma_f32_16x16x32_bf16 v[8:11], v[28:31], v[64:67], v[8:11]
    v_mfma_f32_16x16x32_bf16 v[8:11], v[32:35], v[68:71], v[8:11]
    v_mfma_f32_16x16x32_bf16 v[8:11], v[36:39], v[72:75], v[8:11]
    v_mfma_f32_16x16x32_bf16 v[8:11], v[40:43], v[76:79], v[8:11]
    v_xor_b32 v62, s65, v22
    s_waitcnt vmcnt(9)
    buffer_load_dwordx4 v[64:67], v62, s[36:39], 0 offen nt
    s_xor_b32 s59, s65, 2146560
    v_xor_b32 v62, s59, v22
    s_waitcnt vmcnt(9)
    buffer_load_dwordx4 v[68:71], v62, s[36:39], 0 offen nt
    s_xor_b32 s59, s65, 74240
    v_xor_b32 v62, s59, v22
    s_waitcnt vmcnt(9)
    buffer_load_dwordx4 v[72:75], v62, s[36:39], 0 offen nt
    s_xor_b32 s59, s65, 2220800
    v_xor_b32 v62, s59, v22
    s_waitcnt vmcnt(9)
    buffer_load_dwordx4 v[76:79], v62, s[36:39], 0 offen nt
    v_mov_b32_dpp v12, v17 row_newbcast:4 row_mask:0xf bank_mask:0x3
    v_mov_b32_dpp v13, v17 row_newbcast:5 row_mask:0xf bank_mask:0x3
    v_mov_b32_dpp v14, v17 row_newbcast:6 row_mask:0xf bank_mask:0x3
    v_mov_b32_dpp v15, v17 row_newbcast:7 row_mask:0xf bank_mask:0x3
    v_mov_b32_dpp v12, v0 row_newbcast:4 row_mask:0xf bank_mask:0xc
    v_mov_b32_dpp v13, v0 row_newbcast:5 row_mask:0xf bank_mask:0xc
    v_mov_b32_dpp v14, v0 row_newbcast:6 row_mask:0xf bank_mask:0xc
    v_mov_b32_dpp v15, v0 row_newbcast:7 row_mask:0xf bank_mask:0xc
    v_and_b32 v28, v12, v4
    v_and_b32 v29, v12, v5
    v_and_b32 v30, v12, v6
    v_and_b32 v31, v12, v7
    v_and_b32 v32, v13, v4
    v_and_b32 v33, v13, v5
    v_and_b32 v34, v13, v6
    v_and_b32 v35, v13, v7
    v_and_b32 v36, v14, v4
    v_and_b32 v37, v14, v5
    v_and_b32 v38, v14, v6
    v_and_b32 v39, v14, v7
    v_and_b32 v40, v15, v4
    v_and_b32 v41, v15, v5
    v_and_b32 v42, v15, v6
    v_and_b32 v43, v15, v7
    s_waitcnt vmcnt(12)
    s_nop 0
    v_mfma_f32_16x16x32_bf16 v[8:11], v[28:31], v[80:83], v[8:11]
    v_mfma_f32_16x16x32_bf16 v[8:11], v[32:35], v[84:87], v[8:11]
    v_mfma_f32_16x16x32_bf16 v[8:11], v[36:39], v[88:91], v[8:11]
    v_mfma_f32_16x16x32_bf16 v[8:11], v[40:43], v[92:95], v[8:11]
    s_xor_b32 s59, s65, 123648
    v_xor_b32 v62, s59, v22
    s_waitcnt vmcnt(9)
    buffer_load_dwordx4 v[80:83], v62, s[36:39], 0 offen nt
    s_xor_b32 s59, s65, 2171392
    v_xor_b32 v62, s59, v22
    s_waitcnt vmcnt(9)
    buffer_load_dwordx4 v[84:87], v62, s[36:39], 0 offen nt
    s_xor_b32 s59, s65, 49408
    v_xor_b32 v62, s59, v22
    s_waitcnt vmcnt(9)
    buffer_load_dwordx4 v[88:91], v62, s[36:39], 0 offen nt
    s_xor_b32 s59, s65, 2097152
    v_xor_b32 v62, s59, v22
    s_waitcnt vmcnt(9)
    buffer_load_dwordx4 v[92:95], v62, s[36:39], 0 offen nt
    v_mov_b32_dpp v12, v17 row_newbcast:8 row_mask:0xf bank_mask:0x3
    v_mov_b32_dpp v13, v17 row_newbcast:9 row_mask:0xf bank_mask:0x3
    v_mov_b32_dpp v14, v17 row_newbcast:10 row_mask:0xf bank_mask:0x3
    v_mov_b32_dpp v15, v17 row_newbcast:11 row_mask:0xf bank_mask:0x3
    v_mov_b32_dpp v12, v0 row_newbcast:8 row_mask:0xf bank_mask:0xc
    v_mov_b32_dpp v13, v0 row_newbcast:9 row_mask:0xf bank_mask:0xc
    v_mov_b32_dpp v14, v0 row_newbcast:10 row_mask:0xf bank_mask:0xc
    v_mov_b32_dpp v15, v0 row_newbcast:11 row_mask:0xf bank_mask:0xc
    v_and_b32 v28, v12, v4
    v_and_b32 v29, v12, v5
    v_and_b32 v30, v12, v6
    v_and_b32 v31, v12, v7
    v_and_b32 v32, v13, v4
    v_and_b32 v33, v13, v5
    v_and_b32 v34, v13, v6
    v_and_b32 v35, v13, v7
    v_and_b32 v36, v14, v4
    v_and_b32 v37, v14, v5
    v_and_b32 v38, v14, v6
    v_and_b32 v39, v14, v7
    v_and_b32 v40, v15, v4
    v_and_b32 v41, v15, v5
    v_and_b32 v42, v15, v6
    v_and_b32 v43, v15, v7
    s_waitcnt vmcnt(12)
    s_nop 0
    v_mfma_f32_16x16x32_bf16 v[8:11], v[28:31], v[96:99], v[8:11]
    v_mfma_f32_16x16x32_bf16 v[8:11], v[32:35], v[100:103], v[8:11]
    v_mfma_f32_16x16x32_bf16 v[8:11], v[36:39], v[104:107], v[8:11]
    v_mfma_f32_16x16x32_bf16 v[8:11], v[40:43], v[108:111], v[8:11]
    s_xor_b32 s59, s65, 14176768
    v_xor_b32 v62, s59, v22
    s_waitcnt vmcnt(9)
    buffer_load_dwordx4 v[96:99], v62, s[36:39], 0 offen nt
    s_xor_b32 s59, s65, 16290560
    v_xor_b32 v62, s59, v22
    s_waitcnt vmcnt(9)
    buffer_load_dwordx4 v[100:103], v62, s[36:39], 0 offen nt
    s_xor_b32 s59, s65, 14249984
    v_xor_b32 v62, s59, v22
    s_waitcnt vmcnt(9)
    buffer_load_dwordx4 v[104:107], v62, s[36:39], 0 offen nt
    s_xor_b32 s59, s65, 16363776
    v_xor_b32 v62, s59, v22
    s_waitcnt vmcnt(9)
    buffer_load_dwordx4 v[108:111], v62, s[36:39], 0 offen nt
    v_mov_b32_dpp v12, v17 row_newbcast:12 row_mask:0xf bank_mask:0x3
    v_mov_b32_dpp v13, v17 row_newbcast:13 row_mask:0xf bank_mask:0x3
    v_mov_b32_dpp v14, v17 row_newbcast:14 row_mask:0xf bank_mask:0x3
    v_mov_b32_dpp v15, v17 row_newbcast:15 row_mask:0xf bank_mask:0x3
    v_mov_b32_dpp v12, v0 row_newbcast:12 row_mask:0xf bank_mask:0xc
    v_mov_b32_dpp v13, v0 row_newbcast:13 row_mask:0xf bank_mask:0xc
    v_mov_b32_dpp v14, v0 row_newbcast:14 row_mask:0xf bank_mask:0xc
    v_mov_b32_dpp v15, v0 row_newbcast:15 row_mask:0xf bank_mask:0xc
    v_and_b32 v28, v12, v4
    v_and_b32 v29, v12, v5
    v_and_b32 v30, v12, v6
    v_and_b32 v31, v12, v7
    v_and_b32 v32, v13, v4
    v_and_b32 v33, v13, v5
    v_and_b32 v34, v13, v6
    v_and_b32 v35, v13, v7
    v_and_b32 v36, v14, v4
    v_and_b32 v37, v14, v5
    v_and_b32 v38, v14, v6
    v_and_b32 v39, v14, v7
    v_and_b32 v40, v15, v4
    v_and_b32 v41, v15, v5
    v_and_b32 v42, v15, v6
    v_and_b32 v43, v15, v7
    s_waitcnt vmcnt(12)
    s_nop 0
    v_mfma_f32_16x16x32_bf16 v[8:11], v[28:31], v[112:115], v[8:11]
    v_mfma_f32_16x16x32_bf16 v[8:11], v[32:35], v[116:119], v[8:11]
    v_mfma_f32_16x16x32_bf16 v[8:11], v[36:39], v[120:123], v[8:11]
    v_mfma_f32_16x16x32_bf16 v[8:11], v[40:43], v[124:127], v[8:11]
    s_xor_b32 s59, s65, 14266624
    v_xor_b32 v62, s59, v22
    s_waitcnt vmcnt(9)
    buffer_load_dwordx4 v[112:115], v62, s[36:39], 0 offen nt
    s_xor_b32 s59, s65, 16347136
    v_xor_b32 v62, s59, v22
    s_waitcnt vmcnt(9)
    buffer_load_dwordx4 v[116:119], v62, s[36:39], 0 offen nt
    s_xor_b32 s59, s65, 14193408
    v_xor_b32 v62, s59, v22
    s_waitcnt vmcnt(9)
    buffer_load_dwordx4 v[120:123], v62, s[36:39], 0 offen nt
    s_xor_b32 s59, s65, 16273920
    v_xor_b32 v62, s59, v22
    s_waitcnt vmcnt(9)
    buffer_load_dwordx4 v[124:127], v62, s[36:39], 0 offen nt
    s_cmp_lt_u32 s72, 59
    s_cbranch_scc1 L_vloop_parallel_sum__mha_block_
    s_mov_b32 s64, s65
    s_add_u32 s72, s72, 1
    v_readlane_b32 s65, v61, s72
    s_xor_b32 s65, s65, s78
    s_waitcnt lgkmcnt(0)
    v_fma_f32 v16, v60, s31, v20
    v_add_u32 v27, 0x100, v27
    v_exp_f32 v16, v16
    ds_read_b32 v60, v27 offset:5632
    v_cvt_pk_bf16_f32 v17, v16, v16
    v_and_b32 v0, s56, v17
    v_sub_f32 v0, v16, v0
    v_cvt_pk_bf16_f32 v0, v0, v0
    v_add_f32 v21, v21, v16
    s_nop 0
    v_mov_b32_dpp v12, v17 row_newbcast:0 row_mask:0xf bank_mask:0x3
    v_mov_b32_dpp v13, v17 row_newbcast:1 row_mask:0xf bank_mask:0x3
    v_mov_b32_dpp v14, v17 row_newbcast:2 row_mask:0xf bank_mask:0x3
    v_mov_b32_dpp v15, v17 row_newbcast:3 row_mask:0xf bank_mask:0x3
    v_mov_b32_dpp v12, v0 row_newbcast:0 row_mask:0xf bank_mask:0xc
    v_mov_b32_dpp v13, v0 row_newbcast:1 row_mask:0xf bank_mask:0xc
    v_mov_b32_dpp v14, v0 row_newbcast:2 row_mask:0xf bank_mask:0xc
    v_mov_b32_dpp v15, v0 row_newbcast:3 row_mask:0xf bank_mask:0xc
    v_and_b32 v28, v12, v4
    v_and_b32 v29, v12, v5
    v_and_b32 v30, v12, v6
    v_and_b32 v31, v12, v7
    v_and_b32 v32, v13, v4
    v_and_b32 v33, v13, v5
    v_and_b32 v34, v13, v6
    v_and_b32 v35, v13, v7
    v_and_b32 v36, v14, v4
    v_and_b32 v37, v14, v5
    v_and_b32 v38, v14, v6
    v_and_b32 v39, v14, v7
    v_and_b32 v40, v15, v4
    v_and_b32 v41, v15, v5
    v_and_b32 v42, v15, v6
    v_and_b32 v43, v15, v7
    s_waitcnt vmcnt(12)
    s_nop 0
    v_mfma_f32_16x16x32_bf16 v[8:11], v[28:31], v[64:67], v[8:11]
    v_mfma_f32_16x16x32_bf16 v[8:11], v[32:35], v[68:71], v[8:11]
    v_mfma_f32_16x16x32_bf16 v[8:11], v[36:39], v[72:75], v[8:11]
    v_mfma_f32_16x16x32_bf16 v[8:11], v[40:43], v[76:79], v[8:11]
    v_mov_b32 v24, 2
    buffer_atomic_add v24, v3, s[40:43], 0 offen sc0 sc1
    v_xor_b32 v62, s65, v22
    buffer_load_dwordx4 v[64:67], v62, s[36:39], 0 offen nt
    s_xor_b32 s59, s65, 2146560
    v_xor_b32 v62, s59, v22
    buffer_load_dwordx4 v[68:71], v62, s[36:39], 0 offen nt
    s_xor_b32 s59, s65, 74240
    v_xor_b32 v62, s59, v22
    buffer_load_dwordx4 v[72:75], v62, s[36:39], 0 offen nt
    s_xor_b32 s59, s65, 2220800
    v_xor_b32 v62, s59, v22
    buffer_load_dwordx4 v[76:79], v62, s[36:39], 0 offen nt
    v_mov_b32_dpp v12, v17 row_newbcast:4 row_mask:0xf bank_mask:0x3
    v_mov_b32_dpp v13, v17 row_newbcast:5 row_mask:0xf bank_mask:0x3
    v_mov_b32_dpp v14, v17 row_newbcast:6 row_mask:0xf bank_mask:0x3
    v_mov_b32_dpp v15, v17 row_newbcast:7 row_mask:0xf bank_mask:0x3
    v_mov_b32_dpp v12, v0 row_newbcast:4 row_mask:0xf bank_mask:0xc
    v_mov_b32_dpp v13, v0 row_newbcast:5 row_mask:0xf bank_mask:0xc
    v_mov_b32_dpp v14, v0 row_newbcast:6 row_mask:0xf bank_mask:0xc
    v_mov_b32_dpp v15, v0 row_newbcast:7 row_mask:0xf bank_mask:0xc
    v_and_b32 v28, v12, v4
    v_and_b32 v29, v12, v5
    v_and_b32 v30, v12, v6
    v_and_b32 v31, v12, v7
    v_and_b32 v32, v13, v4
    v_and_b32 v33, v13, v5
    v_and_b32 v34, v13, v6
    v_and_b32 v35, v13, v7
    v_and_b32 v36, v14, v4
    v_and_b32 v37, v14, v5
    v_and_b32 v38, v14, v6
    v_and_b32 v39, v14, v7
    v_and_b32 v40, v15, v4
    v_and_b32 v41, v15, v5
    v_and_b32 v42, v15, v6
    v_and_b32 v43, v15, v7
    s_waitcnt vmcnt(13)
    s_nop 0
    v_mfma_f32_16x16x32_bf16 v[8:11], v[28:31], v[80:83], v[8:11]
    v_mfma_f32_16x16x32_bf16 v[8:11], v[32:35], v[84:87], v[8:11]
    v_mfma_f32_16x16x32_bf16 v[8:11], v[36:39], v[88:91], v[8:11]
    v_mfma_f32_16x16x32_bf16 v[8:11], v[40:43], v[92:95], v[8:11]
    s_xor_b32 s59, s65, 123648
    v_xor_b32 v62, s59, v22
    buffer_load_dwordx4 v[80:83], v62, s[36:39], 0 offen nt
    s_xor_b32 s59, s65, 2171392
    v_xor_b32 v62, s59, v22
    buffer_load_dwordx4 v[84:87], v62, s[36:39], 0 offen nt
    s_xor_b32 s59, s65, 49408
    v_xor_b32 v62, s59, v22
    buffer_load_dwordx4 v[88:91], v62, s[36:39], 0 offen nt
    s_xor_b32 s59, s65, 2097152
    v_xor_b32 v62, s59, v22
    buffer_load_dwordx4 v[92:95], v62, s[36:39], 0 offen nt
    v_mov_b32_dpp v12, v17 row_newbcast:8 row_mask:0xf bank_mask:0x3
    v_mov_b32_dpp v13, v17 row_newbcast:9 row_mask:0xf bank_mask:0x3
    v_mov_b32_dpp v14, v17 row_newbcast:10 row_mask:0xf bank_mask:0x3
    v_mov_b32_dpp v15, v17 row_newbcast:11 row_mask:0xf bank_mask:0x3
    v_mov_b32_dpp v12, v0 row_newbcast:8 row_mask:0xf bank_mask:0xc
    v_mov_b32_dpp v13, v0 row_newbcast:9 row_mask:0xf bank_mask:0xc
    v_mov_b32_dpp v14, v0 row_newbcast:10 row_mask:0xf bank_mask:0xc
    v_mov_b32_dpp v15, v0 row_newbcast:11 row_mask:0xf bank_mask:0xc
    v_and_b32 v28, v12, v4
    v_and_b32 v29, v12, v5
    v_and_b32 v30, v12, v6
    v_and_b32 v31, v12, v7
    v_and_b32 v32, v13, v4
    v_and_b32 v33, v13, v5
    v_and_b32 v34, v13, v6
    v_and_b32 v35, v13, v7
    v_and_b32 v36, v14, v4
    v_and_b32 v37, v14, v5
    v_and_b32 v38, v14, v6
    v_and_b32 v39, v14, v7
    v_and_b32 v40, v15, v4
    v_and_b32 v41, v15, v5
    v_and_b32 v42, v15, v6
    v_and_b32 v43, v15, v7
    s_waitcnt vmcnt(13)
    s_nop 0
    v_mfma_f32_16x16x32_bf16 v[8:11], v[28:31], v[96:99], v[8:11]
    v_mfma_f32_16x16x32_bf16 v[8:11], v[32:35], v[100:103], v[8:11]
    v_mfma_f32_16x16x32_bf16 v[8:11], v[36:39], v[104:107], v[8:11]
    v_mfma_f32_16x16x32_bf16 v[8:11], v[40:43], v[108:111], v[8:11]
    s_xor_b32 s59, s65, 14176768
    v_xor_b32 v62, s59, v22
    buffer_load_dwordx4 v[96:99], v62, s[36:39], 0 offen nt
    s_xor_b32 s59, s65, 16290560
    v_xor_b32 v62, s59, v22
    buffer_load_dwordx4 v[100:103], v62, s[36:39], 0 offen nt
    s_xor_b32 s59, s65, 14249984
    v_xor_b32 v62, s59, v22
    buffer_load_dwordx4 v[104:107], v62, s[36:39], 0 offen nt
    s_xor_b32 s59, s65, 16363776
    v_xor_b32 v62, s59, v22
    buffer_load_dwordx4 v[108:111], v62, s[36:39], 0 offen nt
    v_mov_b32_dpp v12, v17 row_newbcast:12 row_mask:0xf bank_mask:0x3
    v_mov_b32_dpp v13, v17 row_newbcast:13 row_mask:0xf bank_mask:0x3
    v_mov_b32_dpp v14, v17 row_newbcast:14 row_mask:0xf bank_mask:0x3
    v_mov_b32_dpp v15, v17 row_newbcast:15 row_mask:0xf bank_mask:0x3
    v_mov_b32_dpp v12, v0 row_newbcast:12 row_mask:0xf bank_mask:0xc
    v_mov_b32_dpp v13, v0 row_newbcast:13 row_mask:0xf bank_mask:0xc
    v_mov_b32_dpp v14, v0 row_newbcast:14 row_mask:0xf bank_mask:0xc
    v_mov_b32_dpp v15, v0 row_newbcast:15 row_mask:0xf bank_mask:0xc
    v_and_b32 v28, v12, v4
    v_and_b32 v29, v12, v5
    v_and_b32 v30, v12, v6
    v_and_b32 v31, v12, v7
    v_and_b32 v32, v13, v4
    v_and_b32 v33, v13, v5
    v_and_b32 v34, v13, v6
    v_and_b32 v35, v13, v7
    v_and_b32 v36, v14, v4
    v_and_b32 v37, v14, v5
    v_and_b32 v38, v14, v6
    v_and_b32 v39, v14, v7
    v_and_b32 v40, v15, v4
    v_and_b32 v41, v15, v5
    v_and_b32 v42, v15, v6
    v_and_b32 v43, v15, v7
    s_waitcnt vmcnt(13)
    s_nop 0
    v_mfma_f32_16x16x32_bf16 v[8:11], v[28:31], v[112:115], v[8:11]
    v_mfma_f32_16x16x32_bf16 v[8:11], v[32:35], v[116:119], v[8:11]
    v_mfma_f32_16x16x32_bf16 v[8:11], v[36:39], v[120:123], v[8:11]
    v_mfma_f32_16x16x32_bf16 v[8:11], v[40:43], v[124:127], v[8:11]
    s_xor_b32 s59, s65, 14266624
    v_xor_b32 v62, s59, v22
    buffer_load_dwordx4 v[112:115], v62, s[36:39], 0 offen nt
    s_xor_b32 s59, s65, 16347136
    v_xor_b32 v62, s59, v22
    buffer_load_dwordx4 v[116:119], v62, s[36:39], 0 offen nt
    s_xor_b32 s59, s65, 14193408
    v_xor_b32 v62, s59, v22
    buffer_load_dwordx4 v[120:123], v62, s[36:39], 0 offen nt
    s_xor_b32 s59, s65, 16273920
    v_xor_b32 v62, s59, v22
    buffer_load_dwordx4 v[124:127], v62, s[36:39], 0 offen nt
    s_mov_b32 s64, s65
    s_waitcnt lgkmcnt(0)
    v_fma_f32 v16, v60, s31, v20
    v_add_u32 v27, 0x100, v27
    v_exp_f32 v16, v16
    ds_read_b32 v60, v27 offset:5632
    v_cvt_pk_bf16_f32 v17, v16, v16
    v_and_b32 v0, s56, v17
    v_sub_f32 v0, v16, v0
    v_cvt_pk_bf16_f32 v0, v0, v0
    v_add_f32 v21, v21, v16
    s_nop 0
    v_mov_b32_dpp v12, v17 row_newbcast:0 row_mask:0xf bank_mask:0x3
    v_mov_b32_dpp v13, v17 row_newbcast:1 row_mask:0xf bank_mask:0x3
    v_mov_b32_dpp v14, v17 row_newbcast:2 row_mask:0xf bank_mask:0x3
    v_mov_b32_dpp v15, v17 row_newbcast:3 row_mask:0xf bank_mask:0x3
    v_mov_b32_dpp v12, v0 row_newbcast:0 row_mask:0xf bank_mask:0xc
    v_mov_b32_dpp v13, v0 row_newbcast:1 row_mask:0xf bank_mask:0xc
    v_mov_b32_dpp v14, v0 row_newbcast:2 row_mask:0xf bank_mask:0xc
    v_mov_b32_dpp v15, v0 row_newbcast:3 row_mask:0xf bank_mask:0xc
    v_and_b32 v28, v12, v4
    v_and_b32 v29, v12, v5
    v_and_b32 v30, v12, v6
    v_and_b32 v31, v12, v7
    v_and_b32 v32, v13, v4
    v_and_b32 v33, v13, v5
    v_and_b32 v34, v13, v6
    v_and_b32 v35, v13, v7
    v_and_b32 v36, v14, v4
    v_and_b32 v37, v14, v5
    v_and_b32 v38, v14, v6
    v_and_b32 v39, v14, v7
    v_and_b32 v40, v15, v4
    v_and_b32 v41, v15, v5
    v_and_b32 v42, v15, v6
    v_and_b32 v43, v15, v7
    s_waitcnt vmcnt(12)
    s_nop 0
    v_mfma_f32_16x16x32_bf16 v[8:11], v[28:31], v[64:67], v[8:11]
    v_mfma_f32_16x16x32_bf16 v[8:11], v[32:35], v[68:71], v[8:11]
    v_mfma_f32_16x16x32_bf16 v[8:11], v[36:39], v[72:75], v[8:11]
    v_mfma_f32_16x16x32_bf16 v[8:11], v[40:43], v[76:79], v[8:11]
    v_readfirstlane_b32 s57, v24
    s_mov_b32 s79, s57
    s_lshr_b32 s58, s57, 6
    s_min_u32 s58, s58, 3
    s_add_u32 s59, s58, 61
    v_readlane_b32 s66, v61, s59
    s_cmp_lt_u32 s58, 3
    s_cselect_b32 s59, s77, 16777216
    s_xor_b32 s66, s66, s59
    s_bitcmp1_b32 s57, 0
    s_cselect_b32 s59, 123648, 0
    s_xor_b32 s66, s66, s59
    s_bitcmp1_b32 s57, 1
    s_cselect_b32 s59, 14176768, 0
    s_xor_b32 s66, s66, s59
    s_bitcmp1_b32 s57, 2
    s_cselect_b32 s59, 13607936, 0
    s_xor_b32 s66, s66, s59
    s_bitcmp1_b32 s57, 3
    s_cselect_b32 s59, 3734784, 0
    s_xor_b32 s66, s66, s59
    s_bitcmp1_b32 s57, 4
    s_cselect_b32 s59, 16222976, 0
    s_xor_b32 s66, s66, s59
    s_bitcmp1_b32 s57, 5
    s_cselect_b32 s59, 7785472, 0
    s_xor_b32 s66, s66, s59
    v_mov_b32 v24, 2
    buffer_atomic_add v24, v3, s[40:43], 0 offen sc0 sc1
    v_xor_b32 v62, s66, v2
    buffer_load_dwordx4 v[64:67], v62, s[32:35], 0 offen nt
    s_xor_b32 s59, s66, 2146560
    v_xor_b32 v62, s59, v2
    buffer_load_dwordx4 v[68:71], v62, s[32:35], 0 offen nt
    s_xor_b32 s59, s66, 74240
    v_xor_b32 v62, s59, v2
    buffer_load_dwordx4 v[72:75], v62, s[32:35], 0 offen nt
    s_xor_b32 s59, s66, 2220800
    v_xor_b32 v62, s59, v2
    buffer_load_dwordx4 v[76:79], v62, s[32:35], 0 offen nt
    v_mov_b32_dpp v12, v17 row_newbcast:4 row_mask:0xf bank_mask:0x3
    v_mov_b32_dpp v13, v17 row_newbcast:5 row_mask:0xf bank_mask:0x3
    v_mov_b32_dpp v14, v17 row_newbcast:6 row_mask:0xf bank_mask:0x3
    v_mov_b32_dpp v15, v17 row_newbcast:7 row_mask:0xf bank_mask:0x3
    v_mov_b32_dpp v12, v0 row_newbcast:4 row_mask:0xf bank_mask:0xc
    v_mov_b32_dpp v13, v0 row_newbcast:5 row_mask:0xf bank_mask:0xc
    v_mov_b32_dpp v14, v0 row_newbcast:6 row_mask:0xf bank_mask:0xc
    v_mov_b32_dpp v15, v0 row_newbcast:7 row_mask:0xf bank_mask:0xc
    v_and_b32 v28, v12, v4
    v_and_b32 v29, v12, v5
    v_and_b32 v30, v12, v6
    v_and_b32 v31, v12, v7
    v_and_b32 v32, v13, v4
    v_and_b32 v33, v13, v5
    v_and_b32 v34, v13, v6
    v_and_b32 v35, v13, v7
    v_and_b32 v36, v14, v4
    v_and_b32 v37, v14, v5
    v_and_b32 v38, v14, v6
    v_and_b32 v39, v14, v7
    v_and_b32 v40, v15, v4
    v_and_b32 v41, v15, v5
    v_and_b32 v42, v15, v6
    v_and_b32 v43, v15, v7
    s_waitcnt vmcnt(13)
    s_nop 0
    v_mfma_f32_16x16x32_bf16 v[8:11], v[28:31], v[80:83], v[8:11]
    v_mfma_f32_16x16x32_bf16 v[8:11], v[32:35], v[84:87], v[8:11]
    v_mfma_f32_16x16x32_bf16 v[8:11], v[36:39], v[88:91], v[8:11]
    v_mfma_f32_16x16x32_bf16 v[8:11], v[40:43], v[92:95], v[8:11]
    v_xor_b32 v62, s66, v22
    buffer_load_dwordx4 v[80:83], v62, s[36:39], 0 offen nt
    s_xor_b32 s59, s66, 2146560
    v_xor_b32 v62, s59, v22
    buffer_load_dwordx4 v[84:87], v62, s[36:39], 0 offen nt
    s_xor_b32 s59, s66, 74240
    v_xor_b32 v62, s59, v22
    buffer_load_dwordx4 v[88:91], v62, s[36:39], 0 offen nt
    s_xor_b32 s59, s66, 2220800
    v_xor_b32 v62, s59, v22
    buffer_load_dwordx4 v[92:95], v62, s[36:39], 0 offen nt
    v_mov_b32_dpp v12, v17 row_newbcast:8 row_mask:0xf bank_mask:0x3
    v_mov_b32_dpp v13, v17 row_newbcast:9 row_mask:0xf bank_mask:0x3
    v_mov_b32_dpp v14, v17 row_newbcast:10 row_mask:0xf bank_mask:0x3
    v_mov_b32_dpp v15, v17 row_newbcast:11 row_mask:0xf bank_mask:0x3
    v_mov_b32_dpp v12, v0 row_newbcast:8 row_mask:0xf bank_mask:0xc
    v_mov_b32_dpp v13, v0 row_newbcast:9 row_mask:0xf bank_mask:0xc
    v_mov_b32_dpp v14, v0 row_newbcast:10 row_mask:0xf bank_mask:0xc
    v_mov_b32_dpp v15, v0 row_newbcast:11 row_mask:0xf bank_mask:0xc
    v_and_b32 v28, v12, v4
    v_and_b32 v29, v12, v5
    v_and_b32 v30, v12, v6
    v_and_b32 v31, v12, v7
    v_and_b32 v32, v13, v4
    v_and_b32 v33, v13, v5
    v_and_b32 v34, v13, v6
    v_and_b32 v35, v13, v7
    v_and_b32 v36, v14, v4
    v_and_b32 v37, v14, v5
    v_and_b32 v38, v14, v6
    v_and_b32 v39, v14, v7
    v_and_b32 v40, v15, v4
    v_and_b32 v41, v15, v5
    v_and_b32 v42, v15, v6
    v_and_b32 v43, v15, v7
    s_waitcnt vmcnt(13)
    s_nop 0
    v_mfma_f32_16x16x32_bf16 v[8:11], v[28:31], v[96:99], v[8:11]
    v_mfma_f32_16x16x32_bf16 v[8:11], v[32:35], v[100:103], v[8:11]
    v_mfma_f32_16x16x32_bf16 v[8:11], v[36:39], v[104:107], v[8:11]
    v_mfma_f32_16x16x32_bf16 v[8:11], v[40:43], v[108:111], v[8:11]
    s_add_u32 s57, s79, 1
    s_lshr_b32 s58, s57, 6
    s_min_u32 s58, s58, 3
    s_add_u32 s59, s58, 61
    v_readlane_b32 s67, v61, s59
    s_cmp_lt_u32 s58, 3
    s_cselect_b32 s59, s77, 16777216
    s_xor_b32 s67, s67, s59
    s_bitcmp1_b32 s57, 0
    s_cselect_b32 s59, 123648, 0
    s_xor_b32 s67, s67, s59
    s_bitcmp1_b32 s57, 1
    s_cselect_b32 s59, 14176768, 0
    s_xor_b32 s67, s67, s59
    s_bitcmp1_b32 s57, 2
    s_cselect_b32 s59, 13607936, 0
    s_xor_b32 s67, s67, s59
    s_bitcmp1_b32 s57, 3
    s_cselect_b32 s59, 3734784, 0
    s_xor_b32 s67, s67, s59
    s_bitcmp1_b32 s57, 4
    s_cselect_b32 s59, 16222976, 0
    s_xor_b32 s67, s67, s59
    s_bitcmp1_b32 s57, 5
    s_cselect_b32 s59, 7785472, 0
    s_xor_b32 s67, s67, s59
    v_xor_b32 v62, s67, v2
    buffer_load_dwordx4 v[96:99], v62, s[32:35], 0 offen nt
    s_xor_b32 s59, s67, 2146560
    v_xor_b32 v62, s59, v2
    buffer_load_dwordx4 v[100:103], v62, s[32:35], 0 offen nt
    s_xor_b32 s59, s67, 74240
    v_xor_b32 v62, s59, v2
    buffer_load_dwordx4 v[104:107], v62, s[32:35], 0 offen nt
    s_xor_b32 s59, s67, 2220800
    v_xor_b32 v62, s59, v2
    buffer_load_dwordx4 v[108:111], v62, s[32:35], 0 offen nt
    v_mov_b32_dpp v12, v17 row_newbcast:12 row_mask:0xf bank_mask:0x3
    v_mov_b32_dpp v13, v17 row_newbcast:13 row_mask:0xf bank_mask:0x3
    v_mov_b32_dpp v14, v17 row_newbcast:14 row_mask:0xf bank_mask:0x3
    v_mov_b32_dpp v15, v17 row_newbcast:15 row_mask:0xf bank_mask:0x3
    v_mov_b32_dpp v12, v0 row_newbcast:12 row_mask:0xf bank_mask:0xc
    v_mov_b32_dpp v13, v0 row_newbcast:13 row_mask:0xf bank_mask:0xc
    v_mov_b32_dpp v14, v0 row_newbcast:14 row_mask:0xf bank_mask:0xc
    v_mov_b32_dpp v15, v0 row_newbcast:15 row_mask:0xf bank_mask:0xc
    v_and_b32 v28, v12, v4
    v_and_b32 v29, v12, v5
    v_and_b32 v30, v12, v6
    v_and_b32 v31, v12, v7
    v_and_b32 v32, v13, v4
    v_and_b32 v33, v13, v5
    v_and_b32 v34, v13, v6
    v_and_b32 v35, v13, v7
    v_and_b32 v36, v14, v4
    v_and_b32 v37, v14, v5
    v_and_b32 v38, v14, v6
    v_and_b32 v39, v14, v7
    v_and_b32 v40, v15, v4
    v_and_b32 v41, v15, v5
    v_and_b32 v42, v15, v6
    v_and_b32 v43, v15, v7
    s_waitcnt vmcnt(13)
    s_nop 0
    v_mfma_f32_16x16x32_bf16 v[8:11], v[28:31], v[112:115], v[8:11]
    v_mfma_f32_16x16x32_bf16 v[8:11], v[32:35], v[116:119], v[8:11]
    v_mfma_f32_16x16x32_bf16 v[8:11], v[36:39], v[120:123], v[8:11]
    v_mfma_f32_16x16x32_bf16 v[8:11], v[40:43], v[124:127], v[8:11]
    v_xor_b32 v62, s67, v22
    buffer_load_dwordx4 v[112:115], v62, s[36:39], 0 offen nt
    s_xor_b32 s59, s67, 2146560
    v_xor_b32 v62, s59, v22
    buffer_load_dwordx4 v[116:119], v62, s[36:39], 0 offen nt
    s_xor_b32 s59, s67, 74240
    v_xor_b32 v62, s59, v22
    buffer_load_dwordx4 v[120:123], v62, s[36:39], 0 offen nt
    s_xor_b32 s59, s67, 2220800
    v_xor_b32 v62, s59, v22
    buffer_load_dwordx4 v[124:127], v62, s[36:39], 0 offen nt
    s_mov_b32 s73, 0x3e800000
L_dloop_parallel_sum__mha_block_:
    s_cmp_ge_u32 s66, 16777216
    s_cbranch_scc1 L_done_parallel_sum__mha_block_
    s_waitcnt vmcnt(12)
    v_mfma_f32_16x16x32_bf16 v[12:15], v[64:67], v[44:47], 0
    v_mfma_f32_16x16x32_bf16 v[12:15], v[68:71], v[48:51], v[12:15]
    v_mfma_f32_16x16x32_bf16 v[12:15], v[72:75], v[52:55], v[12:15]
    v_mfma_f32_16x16x32_bf16 v[12:15], v[76:79], v[56:59], v[12:15]
    v_readfirstlane_b32 s57, v24
    s_mov_b32 s79, s57
    s_lshr_b32 s58, s57, 6
    s_min_u32 s58, s58, 3
    s_add_u32 s59, s58, 61
    v_readlane_b32 s66, v61, s59
    s_cmp_lt_u32 s58, 3
    s_cselect_b32 s59, s77, 16777216
    s_xor_b32 s66, s66, s59
    s_bitcmp1_b32 s57, 0
    s_cselect_b32 s59, 123648, 0
    s_xor_b32 s66, s66, s59
    s_bitcmp1_b32 s57, 1
    s_cselect_b32 s59, 14176768, 0
    s_xor_b32 s66, s66, s59
    s_bitcmp1_b32 s57, 2
    s_cselect_b32 s59, 13607936, 0
    s_xor_b32 s66, s66, s59
    s_bitcmp1_b32 s57, 3
    s_cselect_b32 s59, 3734784, 0
    s_xor_b32 s66, s66, s59
    s_bitcmp1_b32 s57, 4
    s_cselect_b32 s59, 16222976, 0
    s_xor_b32 s66, s66, s59
    s_bitcmp1_b32 s57, 5
    s_cselect_b32 s59, 7785472, 0
    s_xor_b32 s66, s66, s59
    v_mov_b32 v24, 2
    buffer_atomic_add v24, v3, s[40:43], 0 offen sc0 sc1
    v_xor_b32 v62, s66, v2
    buffer_load_dwordx4 v[64:67], v62, s[32:35], 0 offen nt
    s_xor_b32 s59, s66, 2146560
    v_xor_b32 v62, s59, v2
    buffer_load_dwordx4 v[68:71], v62, s[32:35], 0 offen nt
    s_xor_b32 s59, s66, 74240
    v_xor_b32 v62, s59, v2
    buffer_load_dwordx4 v[72:75], v62, s[32:35], 0 offen nt
    s_xor_b32 s59, s66, 2220800
    v_xor_b32 v62, s59, v2
    buffer_load_dwordx4 v[76:79], v62, s[32:35], 0 offen nt
    v_mov_b32_dpp v12, v13 quad_perm:[0,1,2,3] row_mask:0xf bank_mask:0x2
    v_mov_b32_dpp v12, v14 quad_perm:[0,1,2,3] row_mask:0xf bank_mask:0x4
    v_mov_b32_dpp v12, v15 quad_perm:[0,1,2,3] row_mask:0xf bank_mask:0x8
    s_nop 1
    v_add_f32_dpp v12, v12, v12 row_ror:4 row_mask:0xf bank_mask:0xf
    s_nop 1
    v_add_f32_dpp v18, v12, v12 row_ror:8 row_mask:0xf bank_mask:0xf
    v_cvt_pk_bf16_f32 v18, v18, v18
    v_and_b32 v18, s56, v18
    v_mul_f32 v18, s30, v18
    v_cvt_pk_bf16_f32 v18, v18, v18
    v_and_b32 v18, s56, v18
    v_cmp_gt_f32 vcc, v18, v19
    s_cbranch_vccnz L_rare0_parallel_sum__mha_block_
L_back0_parallel_sum__mha_block_:
    v_fma_f32 v16, v18, s31, v20
    v_exp_f32 v16, v16
    s_nop 0
    v_cvt_pk_bf16_f32 v17, v16, v16
    v_and_b32 v0, s56, v17
    v_sub_f32 v0, v16, v0
    v_cvt_pk_bf16_f32 v0, v0, v0
    v_fma_f32 v21, v16, s73, v21
    s_nop 0
    v_mov_b32_dpp v12, v17 row_newbcast:0 row_mask:0xf bank_mask:0x3
    v_mov_b32_dpp v13, v17 row_newbcast:1 row_mask:0xf bank_mask:0x3
    v_mov_b32_dpp v14, v17 row_newbcast:2 row_mask:0xf bank_mask:0x3
    v_mov_b32_dpp v15, v17 row_newbcast:3 row_mask:0xf bank_mask:0x3
    v_mov_b32_dpp v12, v0 row_newbcast:0 row_mask:0xf bank_mask:0xc
    v_mov_b32_dpp v13, v0 row_newbcast:1 row_mask:0xf bank_mask:0xc
    v_mov_b32_dpp v14, v0 row_newbcast:2 row_mask:0xf bank_mask:0xc
    v_mov_b32_dpp v15, v0 row_newbcast:3 row_mask:0xf bank_mask:0xc
    v_and_b32 v28, v12, v4
    v_and_b32 v29, v12, v5
    v_and_b32 v30, v12, v6
    v_and_b32 v31, v12, v7
    v_and_b32 v32, v13, v4
    v_and_b32 v33, v13, v5
    v_and_b32 v34, v13, v6
    v_and_b32 v35, v13, v7
    v_and_b32 v36, v14, v4
    v_and_b32 v37, v14, v5
    v_and_b32 v38, v14, v6
    v_and_b32 v39, v14, v7
    v_and_b32 v40, v15, v4
    v_and_b32 v41, v15, v5
    v_and_b32 v42, v15, v6
    v_and_b32 v43, v15, v7
    s_waitcnt vmcnt(13)
    s_nop 0
    v_mfma_f32_16x16x32_bf16 v[8:11], v[28:31], v[80:83], v[8:11]
    v_mfma_f32_16x16x32_bf16 v[8:11], v[32:35], v[84:87], v[8:11]
    v_mfma_f32_16x16x32_bf16 v[8:11], v[36:39], v[88:91], v[8:11]
    v_mfma_f32_16x16x32_bf16 v[8:11], v[40:43], v[92:95], v[8:11]
    v_xor_b32 v62, s66, v22
    buffer_load_dwordx4 v[80:83], v62, s[36:39], 0 offen nt
    s_xor_b32 s59, s66, 2146560
    v_xor_b32 v62, s59, v22
    buffer_load_dwordx4 v[84:87], v62, s[36:39], 0 offen nt
    s_xor_b32 s59, s66, 74240
    v_xor_b32 v62, s59, v22
    buffer_load_dwordx4 v[88:91], v62, s[36:39], 0 offen nt
    s_xor_b32 s59, s66, 2220800
    v_xor_b32 v62, s59, v22
    buffer_load_dwordx4 v[92:95], v62, s[36:39], 0 offen nt
    s_cmp_ge_u32 s67, 16777216
    s_cbranch_scc1 L_done_parallel_sum__mha_block_
    s_waitcnt vmcnt(13)
    v_mfma_f32_16x16x32_bf16 v[12:15], v[96:99], v[44:47], 0
    v_mfma_f32_16x16x32_bf16 v[12:15], v[100:103], v[48:51], v[12:15]
    v_mfma_f32_16x16x32_bf16 v[12:15], v[104:107], v[52:55], v[12:15]
    v_mfma_f32_16x16x32_bf16 v[12:15], v[108:111], v[56:59], v[12:15]
    s_add_u32 s57, s79, 1
    s_lshr_b32 s58, s57, 6
    s_min_u32 s58, s58, 3
    s_add_u32 s59, s58, 61
    v_readlane_b32 s67, v61, s59
    s_cmp_lt_u32 s58, 3
    s_cselect_b32 s59, s77, 16777216
    s_xor_b32 s67, s67, s59
    s_bitcmp1_b32 s57, 0
    s_cselect_b32 s59, 123648, 0
    s_xor_b32 s67, s67, s59
    s_bitcmp1_b32 s57, 1
    s_cselect_b32 s59, 14176768, 0
    s_xor_b32 s67, s67, s59
    s_bitcmp1_b32 s57, 2
    s_cselect_b32 s59, 13607936, 0
    s_xor_b32 s67, s67, s59
    s_bitcmp1_b32 s57, 3
    s_cselect_b32 s59, 3734784, 0
    s_xor_b32 s67, s67, s59
    s_bitcmp1_b32 s57, 4
    s_cselect_b32 s59, 16222976, 0
    s_xor_b32 s67, s67, s59
    s_bitcmp1_b32 s57, 5
    s_cselect_b32 s59, 7785472, 0
    s_xor_b32 s67, s67, s59
    v_xor_b32 v62, s67, v2
    buffer_load_dwordx4 v[96:99], v62, s[32:35], 0 offen nt
    s_xor_b32 s59, s67, 2146560
    v_xor_b32 v62, s59, v2
    buffer_load_dwordx4 v[100:103], v62, s[32:35], 0 offen nt
    s_xor_b32 s59, s67, 74240
    v_xor_b32 v62, s59, v2
    buffer_load_dwordx4 v[104:107], v62, s[32:35], 0 offen nt
    s_xor_b32 s59, s67, 2220800
    v_xor_b32 v62, s59, v2
    buffer_load_dwordx4 v[108:111], v62, s[32:35], 0 offen nt
    v_mov_b32_dpp v12, v13 quad_perm:[0,1,2,3] row_mask:0xf bank_mask:0x2
    v_mov_b32_dpp v12, v14 quad_perm:[0,1,2,3] row_mask:0xf bank_mask:0x4
    v_mov_b32_dpp v12, v15 quad_perm:[0,1,2,3] row_mask:0xf bank_mask:0x8
    s_nop 1
    v_add_f32_dpp v12, v12, v12 row_ror:4 row_mask:0xf bank_mask:0xf
    s_nop 1
    v_add_f32_dpp v18, v12, v12 row_ror:8 row_mask:0xf bank_mask:0xf
    v_cvt_pk_bf16_f32 v18, v18, v18
    v_and_b32 v18, s56, v18
    v_mul_f32 v18, s30, v18
    v_cvt_pk_bf16_f32 v18, v18, v18
    v_and_b32 v18, s56, v18
    v_cmp_gt_f32 vcc, v18, v19
    s_cbranch_vccnz L_rare1_parallel_sum__mha_block_
L_back1_parallel_sum__mha_block_:
    v_fma_f32 v16, v18, s31, v20
    v_exp_f32 v16, v16
    s_nop 0
    v_cvt_pk_bf16_f32 v17, v16, v16
    v_and_b32 v0, s56, v17
    v_sub_f32 v0, v16, v0
    v_cvt_pk_bf16_f32 v0, v0, v0
    v_fma_f32 v21, v16, s73, v21
    s_nop 0
    v_mov_b32_dpp v12, v17 row_newbcast:0 row_mask:0xf bank_mask:0x3
    v_mov_b32_dpp v13, v17 row_newbcast:1 row_mask:0xf bank_mask:0x3
    v_mov_b32_dpp v14, v17 row_newbcast:2 row_mask:0xf bank_mask:0x3
    v_mov_b32_dpp v15, v17 row_newbcast:3 row_mask:0xf bank_mask:0x3
    v_mov_b32_dpp v12, v0 row_newbcast:0 row_mask:0xf bank_mask:0xc
    v_mov_b32_dpp v13, v0 row_newbcast:1 row_mask:0xf bank_mask:0xc
    v_mov_b32_dpp v14, v0 row_newbcast:2 row_mask:0xf bank_mask:0xc
    v_mov_b32_dpp v15, v0 row_newbcast:3 row_mask:0xf bank_mask:0xc
    v_and_b32 v28, v12, v4
    v_and_b32 v29, v12, v5
    v_and_b32 v30, v12, v6
    v_and_b32 v31, v12, v7
    v_and_b32 v32, v13, v4
    v_and_b32 v33, v13, v5
    v_and_b32 v34, v13, v6
    v_and_b32 v35, v13, v7
    v_and_b32 v36, v14, v4
    v_and_b32 v37, v14, v5
    v_and_b32 v38, v14, v6
    v_and_b32 v39, v14, v7
    v_and_b32 v40, v15, v4
    v_and_b32 v41, v15, v5
    v_and_b32 v42, v15, v6
    v_and_b32 v43, v15, v7
    s_waitcnt vmcnt(13)
    s_nop 0
    v_mfma_f32_16x16x32_bf16 v[8:11], v[28:31], v[112:115], v[8:11]
    v_mfma_f32_16x16x32_bf16 v[8:11], v[32:35], v[116:119], v[8:11]
    v_mfma_f32_16x16x32_bf16 v[8:11], v[36:39], v[120:123], v[8:11]
    v_mfma_f32_16x16x32_bf16 v[8:11], v[40:43], v[124:127], v[8:11]
    v_xor_b32 v62, s67, v22
    buffer_load_dwordx4 v[112:115], v62, s[36:39], 0 offen nt
    s_xor_b32 s59, s67, 2146560
    v_xor_b32 v62, s59, v22
    buffer_load_dwordx4 v[116:119], v62, s[36:39], 0 offen nt
    s_xor_b32 s59, s67, 74240
    v_xor_b32 v62, s59, v22
    buffer_load_dwordx4 v[120:123], v62, s[36:39], 0 offen nt
    s_xor_b32 s59, s67, 2220800
    v_xor_b32 v62, s59, v22
    buffer_load_dwordx4 v[124:127], v62, s[36:39], 0 offen nt
    s_branch L_dloop_parallel_sum__mha_block_
L_rare0_parallel_sum__mha_block_:
    v_max_f32 v12, v18, v19
    s_nop 1
    v_max_f32_dpp v12, v12, v12 quad_perm:[1,0,3,2] row_mask:0xf bank_mask:0xf
    s_nop 1
    v_max_f32_dpp v12, v12, v12 quad_perm:[2,3,0,1] row_mask:0xf bank_mask:0xf
    s_nop 1
    v_max_f32_dpp v12, v12, v12 row_half_mirror row_mask:0xf bank_mask:0xf
    s_nop 1
    v_max_f32_dpp v12, v12, v12 row_mirror row_mask:0xf bank_mask:0xf
    v_mov_b32 v16, v12
    s_nop 1
    v_permlane16_swap_b32 v12, v16
    s_nop 1
    v_max_f32 v12, v12, v16
    v_mov_b32 v16, v12
    s_nop 1
    v_permlane32_swap_b32 v12, v16
    s_nop 1
    v_max_f32 v12, v12, v16
    v_sub_f32 v16, v19, v12
    v_mul_f32 v16, s31, v16
    v_exp_f32 v16, v16
    v_mov_b32 v19, v12
    v_mul_f32 v20, s31, v12
    v_sub_f32 v20, 0, v20
    v_mul_f32 v8, v8, v16
    v_mul_f32 v9, v9, v16
    v_mul_f32 v10, v10, v16
    v_mul_f32 v11, v11, v16
    v_mul_f32 v21, v21, v16
    s_branch L_back0_parallel_sum__mha_block_
L_rare1_parallel_sum__mha_block_:
    v_max_f32 v12, v18, v19
    s_nop 1
    v_max_f32_dpp v12, v12, v12 quad_perm:[1,0,3,2] row_mask:0xf bank_mask:0xf
    s_nop 1
    v_max_f32_dpp v12, v12, v12 quad_perm:[2,3,0,1] row_mask:0xf bank_mask:0xf
    s_nop 1
    v_max_f32_dpp v12, v12, v12 row_half_mirror row_mask:0xf bank_mask:0xf
    s_nop 1
    v_max_f32_dpp v12, v12, v12 row_mirror row_mask:0xf bank_mask:0xf
    v_mov_b32 v16, v12
    s_nop 1
    v_permlane16_swap_b32 v12, v16
    s_nop 1
    v_max_f32 v12, v12, v16
    v_mov_b32 v16, v12
    s_nop 1
    v_permlane32_swap_b32 v12, v16
    s_nop 1
    v_max_f32 v12, v12, v16
    v_sub_f32 v16, v19, v12
    v_mul_f32 v16, s31, v16
    v_exp_f32 v16, v16
    v_mov_b32 v19, v12
    v_mul_f32 v20, s31, v12
    v_sub_f32 v20, 0, v20
    v_mul_f32 v8, v8, v16
    v_mul_f32 v9, v9, v16
    v_mul_f32 v10, v10, v16
    v_mul_f32 v11, v11, v16
    v_mul_f32 v21, v21, v16
    s_branch L_back1_parallel_sum__mha_block_
L_done_parallel_sum__mha_block_:
    ds_write_b32 v63, v63 offset:4648
    v_mov_b32 v12, v8
    v_mov_b32 v13, v9
    v_mov_b32 v14, v10
    v_mov_b32 v15, v11
    v_permlane32_swap_b32 v8, v12
    v_permlane32_swap_b32 v9, v13
    v_permlane32_swap_b32 v10, v14
    v_permlane32_swap_b32 v11, v15
    v_add_f32 v8, v8, v12
    v_add_f32 v9, v9, v13
    v_add_f32 v10, v10, v14
    v_add_f32 v11, v11, v15
    s_nop 1
    v_add_f32_dpp v21, v21, v21 quad_perm:[1,0,3,2] row_mask:0xf bank_mask:0xf
    s_nop 1
    v_add_f32_dpp v21, v21, v21 quad_perm:[2,3,0,1] row_mask:0xf bank_mask:0xf
    s_nop 1
    v_add_f32_dpp v21, v21, v21 row_half_mirror row_mask:0xf bank_mask:0xf
    s_nop 1
    v_add_f32_dpp v21, v21, v21 row_mirror row_mask:0xf bank_mask:0xf
    v_mov_b32 v16, v21
    s_nop 1
    v_permlane16_swap_b32 v21, v16
    s_nop 1
    v_add_f32 v21, v21, v16
    v_mov_b32 v16, v21
    s_nop 1
    v_permlane32_swap_b32 v21, v16
    s_nop 1
    v_add_f32 v21, v21, v16
    s_lshl_b32 s57, s3, 2
    v_mov_b32 v16, s57
    ds_write_b128 v23, v[8:11] offset:2560
    ds_write_b32 v16, v19 offset:4608
    ds_write_b32 v16, v21 offset:4624
    s_waitcnt lgkmcnt(0)
    s_barrier
    s_lshl_b32 s57, s29, 2
    s_xor_b32 s57, s57, s28
    s_xor_b32 s58, s3, 1
    s_or_b32 s57, s57, s58
    s_cmp_lg_u32 s57, 0
    s_cbranch_scc1 L_end_parallel_sum__mha_block_
    s_waitcnt vmcnt(0)
    s_lshl_b32 s57, s29, 13
    s_add_u32 s58, s57, 524288
    v_add_u32 v13, s58, v3
    v_add_u32 v15, 0x1000, v13
    s_lshl_b32 s57, s29, 7
    v_and_b32 v16, 15, v1
    v_lshlrev_b32 v17, 4, v16
    v_lshlrev_b32 v16, 3, v16
    v_add_u32 v16, s57, v16
    global_load_dwordx2 v[18:19], v16, s[4:5]
    ds_read_b128 v[64:67], v17 offset:4672
    global_load_dwordx4 v[100:103], v13, s[26:27] offset:0 sc1
    global_load_dwordx4 v[104:107], v13, s[26:27] offset:1024 sc1
    global_load_dwordx4 v[108:111], v13, s[26:27] offset:2048 sc1
    global_load_dwordx4 v[112:115], v13, s[26:27] offset:3072 sc1
    global_load_dwordx4 v[116:119], v15, s[26:27] offset:0 sc1
    global_load_dwordx4 v[120:123], v15, s[26:27] offset:1024 sc1
    global_load_dwordx4 v[124:127], v15, s[26:27] offset:2048 sc1
    global_load_dwordx4 v[128:131], v15, s[26:27] offset:3072 sc1
    s_waitcnt vmcnt(8) lgkmcnt(0)
    s_mul_i32 s61, s61, 0x9e3779b1
    s_add_u32 s61, s61, 0x7f4a7c15
    s_mov_b32 s64, s61
    s_lshr_b32 s65, s61, 8
    s_lshr_b32 s66, s61, 16
    s_lshr_b32 s67, s61, 24
    v_lshlrev_b32 v28, 16, v18
    v_and_b32 v29, s56, v18
    v_lshlrev_b32 v30, 16, v19
    v_and_b32 v31, s56, v19
    s_mov_b32 s60, 300000
L_fpoll0_parallel_sum__mha_block_:
    s_mov_b32 s69, 0
L_fpoll_parallel_sum__mha_block_:
    s_waitcnt vmcnt(0)
    v_xor_b32 v20, s64, v100
    v_bitop3_b32 v20, v20, v101, s65 bitop3:0xf6
    v_bitop3_b32 v20, v20, v102, s66 bitop3:0xf6
    v_bitop3_b32 v20, v20, v103, s67 bitop3:0xf6
    v_bitop3_b32 v20, v20, v104, s64 bitop3:0xf6
    v_bitop3_b32 v20, v20, v105, s65 bitop3:0xf6
    v_bitop3_b32 v20, v20, v106, s66 bitop3:0xf6
    v_bitop3_b32 v20, v20, v107, s67 bitop3:0xf6
    v_bitop3_b32 v20, v20, v108, s64 bitop3:0xf6
    v_bitop3_b32 v20, v20, v109, s65 bitop3:0xf6
    v_bitop3_b32 v20, v20, v110, s66 bitop3:0xf6
    v_bitop3_b32 v20, v20, v111, s67 bitop3:0xf6
    v_bitop3_b32 v20, v20, v112, s64 bitop3:0xf6
    v_bitop3_b32 v20, v20, v113, s65 bitop3:0xf6
    v_bitop3_b32 v20, v20, v114, s66 bitop3:0xf6
    v_bitop3_b32 v20, v20, v115, s67 bitop3:0xf6
    v_bitop3_b32 v20, v20, v116, s64 bitop3:0xf6
    v_bitop3_b32 v20, v20, v117, s65 bitop3:0xf6
    v_bitop3_b32 v20, v20, v118, s66 bitop3:0xf6
    v_bitop3_b32 v20, v20, v119, s67 bitop3:0xf6
    v_bitop3_b32 v20, v20, v120, s64 bitop3:0xf6
    v_bitop3_b32 v20, v20, v121, s65 bitop3:0xf6
    v_bitop3_b32 v20, v20, v122, s66 bitop3:0xf6
    v_bitop3_b32 v20, v20, v123, s67 bitop3:0xf6
    v_bitop3_b32 v20, v20, v124, s64 bitop3:0xf6
    v_bitop3_b32 v20, v20, v125, s65 bitop3:0xf6
    v_bitop3_b32 v20, v20, v126, s66 bitop3:0xf6
    v_bitop3_b32 v20, v20, v127, s67 bitop3:0xf6
    v_bitop3_b32 v20, v20, v128, s64 bitop3:0xf6
    v_bitop3_b32 v20, v20, v129, s65 bitop3:0xf6
    v_bitop3_b32 v20, v20, v130, s66 bitop3:0xf6
    v_bitop3_b32 v20, v20, v131, s67 bitop3:0xf6
    v_and_b32 v20, 31, v20
    v_cmp_ne_u32 vcc, 0, v20
    s_cbranch_vccz L_fuse0_parallel_sum__mha_block_
    global_load_dwordx4 v[100:103], v13, s[26:27] offset:0 sc1
    global_load_dwordx4 v[104:107], v13, s[26:27] offset:1024 sc1
    global_load_dwordx4 v[108:111], v13, s[26:27] offset:2048 sc1
    global_load_dwordx4 v[112:115], v13, s[26:27] offset:3072 sc1
    global_load_dwordx4 v[116:119], v15, s[26:27] offset:0 sc1
    global_load_dwordx4 v[120:123], v15, s[26:27] offset:1024 sc1
    global_load_dwordx4 v[124:127], v15, s[26:27] offset:2048 sc1
    global_load_dwordx4 v[128:131], v15, s[26:27] offset:3072 sc1
    s_sub_u32 s60, s60, 1
    s_cmp_lg_u32 s60, 0
    s_cbranch_scc1 L_fpoll_parallel_sum__mha_block_
L_fuse0_parallel_sum__mha_block_:
    s_cmp_eq_u32 s69, 0
    v_and_b32 v68, s55, v100
    v_and_b32 v69, s55, v101
    v_and_b32 v70, s55, v102
    v_and_b32 v71, s55, v103
    v_and_b32 v72, s55, v104
    v_and_b32 v73, s55, v105
    v_and_b32 v74, s55, v106
    v_and_b32 v75, s55, v107
    v_and_b32 v76, s55, v108
    v_and_b32 v77, s55, v109
    v_and_b32 v78, s55, v110
    v_and_b32 v79, s55, v111
    v_and_b32 v80, s55, v112
    v_and_b32 v81, s55, v113
    v_and_b32 v82, s55, v114
    v_and_b32 v83, s55, v115
    v_and_b32 v84, s55, v116
    v_and_b32 v85, s55, v117
    v_and_b32 v86, s55, v118
    v_and_b32 v87, s55, v119
    v_and_b32 v88, s55, v120
    v_and_b32 v89, s55, v121
    v_and_b32 v90, s55, v122
    v_and_b32 v91, s55, v123
    v_and_b32 v92, s55, v124
    v_and_b32 v93, s55, v125
    v_and_b32 v94, s55, v126
    v_and_b32 v95, s55, v127
    v_and_b32 v96, s55, v128
    v_and_b32 v97, s55, v129
    v_and_b32 v98, s55, v130
    v_and_b32 v99, s55, v131
L_fgo_parallel_sum__mha_block_:
    v_add_f32 v68, v68, v72
    v_add_f32 v69, v69, v73
    v_add_f32 v70, v70, v74
    v_add_f32 v71, v71, v75
    v_add_f32 v76, v76, v80
    v_add_f32 v77, v77, v81
    v_add_f32 v78, v78, v82
    v_add_f32 v79, v79, v83
    v_add_f32 v84, v84, v88
    v_add_f32 v85, v85, v89
    v_add_f32 v86, v86, v90
    v_add_f32 v87, v87, v91
    v_add_f32 v92, v92, v96
    v_add_f32 v93, v93, v97
    v_add_f32 v94, v94, v98
    v_add_f32 v95, v95, v99
    v_add_f32 v68, v68, v76
    v_add_f32 v69, v69, v77
    v_add_f32 v70, v70, v78
    v_add_f32 v71, v71, v79
    v_add_f32 v84, v84, v92
    v_add_f32 v85, v85, v93
    v_add_f32 v86, v86, v94
    v_add_f32 v87, v87, v95
    v_add_f32 v68, v68, v84
    v_add_f32 v69, v69, v85
    v_add_f32 v70, v70, v86
    v_add_f32 v71, v71, v87
    v_mov_b32 v72, v68
    v_mov_b32 v73, v69
    v_mov_b32 v74, v70
    v_mov_b32 v75, v71
    v_permlane16_swap_b32 v68, v72
    v_permlane16_swap_b32 v69, v73
    v_permlane16_swap_b32 v70, v74
    v_permlane16_swap_b32 v71, v75
    v_add_f32 v68, v68, v72
    v_add_f32 v69, v69, v73
    v_add_f32 v70, v70, v74
    v_add_f32 v71, v71, v75
    v_mov_b32 v72, v68
    v_mov_b32 v73, v69
    v_mov_b32 v74, v70
    v_mov_b32 v75, v71
    v_permlane32_swap_b32 v68, v72
    v_permlane32_swap_b32 v69, v73
    v_permlane32_swap_b32 v70, v74
    v_permlane32_swap_b32 v71, v75
    v_add_f32 v68, v68, v72
    v_add_f32 v69, v69, v73
    v_add_f32 v70, v70, v74
    v_add_f32 v71, v71, v75
    v_cvt_pk_bf16_f32 v68, v68, v68
    v_cvt_pk_bf16_f32 v69, v69, v69
    v_cvt_pk_bf16_f32 v70, v70, v70
    v_cvt_pk_bf16_f32 v71, v71, v71
    v_and_b32 v68, s56, v68
    v_and_b32 v69, s56, v69
    v_and_b32 v70, s56, v70
    v_and_b32 v71, s56, v71
    v_add_f32 v24, v28, v68
    v_add_f32 v25, v29, v69
    v_add_f32 v26, v30, v70
    v_add_f32 v27, v31, v71
    v_cvt_pk_bf16_f32 v24, v24, v24
    v_cvt_pk_bf16_f32 v25, v25, v25
    v_cvt_pk_bf16_f32 v26, v26, v26
    v_cvt_pk_bf16_f32 v27, v27, v27
    v_and_b32 v24, s56, v24
    v_and_b32 v25, s56, v25
    v_and_b32 v26, s56, v26
    v_and_b32 v27, s56, v27
    v_add_f32 v24, v24, v64
    v_add_f32 v25, v25, v65
    v_add_f32 v26, v26, v66
    v_add_f32 v27, v27, v67
    v_cvt_pk_bf16_f32 v24, v24, v25
    v_cvt_pk_bf16_f32 v25, v26, v27
    s_cbranch_scc0 L_fpoll0_parallel_sum__mha_block_
    s_mov_b64 exec, 0xffff
    global_store_dwordx2 v16, v[24:25], s[22:23]
    s_cmp_lg_u32 s29, 0
    s_cbranch_scc1 L_end_parallel_sum__mha_block_
    s_mov_b64 exec, 1
    v_mov_b32 v16, 1024000
    v_mov_b32 v17, s61
    global_store_dword v16, v17, s[26:27]
    s_branch L_end_parallel_sum__mha_block_
L_aux_parallel_sum__mha_block_:
    s_setprio 3
    v_mov_b32 v58, 0
    v_mov_b32 v59, 0
    v_mov_b32 v60, 1
    v_mov_b32 v61, 1
    ds_write_b128 v59, v[58:61] offset:4640
    v_lshrrev_b32 v52, 4, v1
    v_and_b32 v53, 15, v1
    v_lshlrev_b32 v46, 4, v53
    v_lshl_add_u32 v46, v52, 17, v46
    s_lshl_b32 s57, s29, 19
    s_lshl_b32 s58, s28, 8
    s_add_u32 s57, s57, s58
    s_sub_u32 s34, 0x400000, s57
    s_mov_b32 s35, 0x20000
    s_waitcnt lgkmcnt(0)
    s_cmp_lg_u32 s29, 0
    s_cbranch_scc1 L_nozero_parallel_sum__mha_block_
    s_mov_b64 exec, 1
    s_add_u32 s58, s58, 655360
    v_mov_b32 v12, s58
    global_store_dword v12, v59, s[26:27] sc1
    s_mov_b64 exec, -1
L_nozero_parallel_sum__mha_block_:
    global_load_dwordx4 v[28:31], v3, s[4:5]
    s_load_dword s61, s[26:27], 1024000
    s_add_u32 s32, s10, s57
    s_addc_u32 s33, s11, 0
    s_mov_b32 s57, 0
    buffer_load_dwordx4 v[64:67], v46, s[32:35], s57 offen nt
    s_add_u32 s57, s57, 8192
    buffer_load_dwordx4 v[68:71], v46, s[32:35], s57 offen nt
    s_add_u32 s57, s57, 8192
    buffer_load_dwordx4 v[72:75], v46, s[32:35], s57 offen nt
    s_add_u32 s57, s57, 8192
    buffer_load_dwordx4 v[76:79], v46, s[32:35], s57 offen nt
    s_add_u32 s57, s57, 8192
    buffer_load_dwordx4 v[80:83], v46, s[32:35], s57 offen nt
    s_add_u32 s57, s57, 8192
    buffer_load_dwordx4 v[84:87], v46, s[32:35], s57 offen nt
    s_add_u32 s57, s57, 8192
    buffer_load_dwordx4 v[88:91], v46, s[32:35], s57 offen nt
    s_add_u32 s57, s57, 8192
    buffer_load_dwordx4 v[92:95], v46, s[32:35], s57 offen nt
    s_add_u32 s57, s57, 8192
    buffer_load_dwordx4 v[96:99], v46, s[32:35], s57 offen nt
    s_add_u32 s57, s57, 8192
    buffer_load_dwordx4 v[100:103], v46, s[32:35], s57 offen nt
    s_add_u32 s57, s57, 8192
    buffer_load_dwordx4 v[104:107], v46, s[32:35], s57 offen nt
    s_add_u32 s57, s57, 8192
    buffer_load_dwordx4 v[108:111], v46, s[32:35], s57 offen nt
    s_add_u32 s57, s57, 8192
    buffer_load_dwordx4 v[112:115], v46, s[32:35], s57 offen nt
    s_add_u32 s57, s57, 8192
    buffer_load_dwordx4 v[116:119], v46, s[32:35], s57 offen nt
    s_add_u32 s57, s57, 8192
    buffer_load_dwordx4 v[120:123], v46, s[32:35], s57 offen nt
    s_add_u32 s57, s57, 8192
    buffer_load_dwordx4 v[124:127], v46, s[32:35], s57 offen nt
    s_add_u32 s57, s57, 8192
    s_barrier
    s_mov_b32 s30, 0x3db504f3
    s_mov_b32 s31, 0x3fb8aa3b
    s_mov_b32 s56, 0xffff0000
    s_mov_b32 s55, 0xffffffe0
    v_and_b32 v8, 1, v1
    v_lshlrev_b32 v8, 4, v8
    v_mov_b32 v9, 0xffff
    v_lshlrev_b32 v8, v8, v9
    v_bfe_u32 v9, v1, 1, 2
    v_cmp_eq_u32 vcc, 0, v9
    s_nop 1
    v_cndmask_b32 v4, 0, v8, vcc
    v_cmp_eq_u32 vcc, 1, v9
    s_nop 1
    v_cndmask_b32 v5, 0, v8, vcc
    v_cmp_eq_u32 vcc, 2, v9
    s_nop 1
    v_cndmask_b32 v6, 0, v8, vcc
    v_cmp_eq_u32 vcc, 3, v9
    s_nop 1
    v_cndmask_b32 v7, 0, v8, vcc
    v_lshrrev_b32 v40, 3, v1
    v_and_b32 v41, 7, v1
    v_lshlrev_b32 v42, 4, v41
    s_mul_i32 s59, s29, 229376
    s_mul_i32 s58, s28, 112
    s_add_u32 s59, s59, s58
    s_add_u32 s40, s16, s59
    s_addc_u32 s41, s17, 0
    s_sub_u32 s42, 1835008, s59
    s_mov_b32 s43, 0x20000
    s_add_u32 s44, s18, s59
    s_addc_u32 s45, s19, 0
    s_mov_b32 s46, s42
    s_mov_b32 s47, 0x20000
    s_mul_i32 s57, s28, 57344
    s_lshl_b32 s58, s29, 7
    s_add_u32 s57, s57, s58
    s_add_u32 s48, s20, s57
    s_addc_u32 s49, s21, 0
    s_sub_u32 s50, 1835008, s57
    s_mov_b32 s51, 0x20000
    s_lshl_b32 s57, s28, 17
    s_add_u32 s57, s57, s58
    s_add_u32 s36, s12, s57
    s_addc_u32 s37, s13, 0
    s_sub_u32 s38, 0x400000, s57
    s_mov_b32 s39, 0x20000
    s_lshl_b32 s62, s28, 13
    s_lshl_b32 s63, s2, 10
    v_add_u32 v43, s63, v3
    s_lshl_b32 s57, s28, 13
    s_add_u32 s57, s57, 262144
    v_add_u32 v56, s57, v3
    v_add_u32 v60, 0x1000, v56
    v_and_b32 v8, 32, v1
    v_lshlrev_b32 v55, 4, v8
    v_lshl_add_u32 v55, v53, 5, v55
    v_and_b32 v8, 16, v1
    s_lshl_b32 s57, s2, 10
    s_add_u32 s57, s57, 262144
    v_add3_u32 v55, v55, v8, s57
    s_lshl_b32 s57, s29, 13
    s_lshl_b32 s58, s28, 8
    s_add_u32 s57, s57, s58
    s_add_u32 s57, s57, 524288
    v_lshlrev_b32 v44, 5, v41
    v_add3_u32 v44, v44, v8, s57
    v_and_b32 v48, 31, v1
    v_lshlrev_b32 v54, 3, v48
    v_lshlrev_b32 v48, 4, v48
    s_mov_b32 s59, 28672
    v_mul_lo_u32 v47, v40, s59
    v_add_u32 v47, v47, v42
    s_mov_b32 s57, 0
    buffer_load_dwordx4 v[192:195], v47, s[40:43], s57 offen nt
    buffer_load_dwordx4 v[196:199], v47, s[44:47], s57 offen nt
    s_add_u32 s57, s57, 3584
    buffer_load_dwordx4 v[200:203], v47, s[40:43], s57 offen nt
    buffer_load_dwordx4 v[204:207], v47, s[44:47], s57 offen nt
    s_add_u32 s57, s57, 3584
    buffer_load_dwordx4 v[208:211], v47, s[40:43], s57 offen nt
    buffer_load_dwordx4 v[212:215], v47, s[44:47], s57 offen nt
    s_add_u32 s57, s57, 3584
    buffer_load_dwordx4 v[216:219], v47, s[40:43], s57 offen nt
    buffer_load_dwordx4 v[220:223], v47, s[44:47], s57 offen nt
    s_add_u32 s57, s57, 3584
    buffer_load_dwordx4 v[224:227], v47, s[40:43], s57 offen nt
    buffer_load_dwordx4 v[228:231], v47, s[44:47], s57 offen nt
    s_add_u32 s57, s57, 3584
    buffer_load_dwordx4 v[232:235], v47, s[40:43], s57 offen nt
    buffer_load_dwordx4 v[236:239], v47, s[44:47], s57 offen nt
    s_add_u32 s57, s57, 3584
    buffer_load_dwordx4 v[240:243], v47, s[40:43], s57 offen nt
    buffer_load_dwordx4 v[244:247], v47, s[44:47], s57 offen nt
    s_add_u32 s57, s57, 3584
    buffer_load_dwordx4 v[248:251], v47, s[40:43], s57 offen nt
    buffer_load_dwordx4 v[252:255], v47, s[44:47], s57 offen nt
    s_add_u32 s57, s57, 3584
    v_lshl_add_u32 v46, v40, 10, v42
    s_mov_b32 s57, 0
    buffer_load_dwordx4 v[128:131], v46, s[48:51], s57 offen nt
    s_add_u32 s57, s57, 8192
    buffer_load_dwordx4 v[132:135], v46, s[48:51], s57 offen nt
    s_add_u32 s57, s57, 8192
    buffer_load_dwordx4 v[136:139], v46, s[48:51], s57 offen nt
    s_add_u32 s57, s57, 8192
    buffer_load_dwordx4 v[140:143], v46, s[48:51], s57 offen nt
    s_add_u32 s57, s57, 8192
    buffer_load_dwordx4 v[144:147], v46, s[48:51], s57 offen nt
    s_add_u32 s57, s57, 8192
    buffer_load_dwordx4 v[148:151], v46, s[48:51], s57 offen nt
    s_add_u32 s57, s57, 8192
    buffer_load_dwordx4 v[152:155], v46, s[48:51], s57 offen nt
    s_add_u32 s57, s57, 8192
    s_waitcnt vmcnt(39)
    v_lshlrev_b32 v32, 16, v28
    v_and_b32 v33, s56, v28
    v_lshlrev_b32 v34, 16, v29
    v_and_b32 v35, s56, v29
    v_lshlrev_b32 v36, 16, v30
    v_and_b32 v37, s56, v30
    v_lshlrev_b32 v38, 16, v31
    v_and_b32 v39, s56, v31
    v_add_f32 v16, v32, v33
    v_add_f32 v17, v34, v35
    v_add_f32 v18, v36, v37
    v_add_f32 v19, v38, v39
    v_add_f32 v16, v16, v17
    v_add_f32 v18, v18, v19
    v_add_f32 v16, v16, v18
    s_nop 1
    v_add_f32_dpp v16, v16, v16 quad_perm:[1,0,3,2] row_mask:0xf bank_mask:0xf
    s_nop 1
    v_add_f32_dpp v16, v16, v16 quad_perm:[2,3,0,1] row_mask:0xf bank_mask:0xf
    s_nop 1
    v_add_f32_dpp v16, v16, v16 row_half_mirror row_mask:0xf bank_mask:0xf
    s_nop 1
    v_add_f32_dpp v16, v16, v16 row_mirror row_mask:0xf bank_mask:0xf
    v_mov_b32 v17, v16
    s_nop 1
    v_permlane16_swap_b32 v16, v17
    s_nop 1
    v_add_f32 v16, v16, v17
    v_mov_b32 v17, v16
    s_nop 1
    v_permlane32_swap_b32 v16, v17
    s_nop 1
    v_add_f32 v16, v16, v17
    v_mul_f32 v16, 0x3b000000, v16
    v_sub_f32 v17, v32, v16
    v_mul_f32 v18, v17, v17
    v_sub_f32 v17, v33, v16
    v_fmac_f32 v18, v17, v17
    v_sub_f32 v17, v34, v16
    v_fmac_f32 v18, v17, v17
    v_sub_f32 v17, v35, v16
    v_fmac_f32 v18, v17, v17
    v_sub_f32 v17, v36, v16
    v_fmac_f32 v18, v17, v17
    v_sub_f32 v17, v37, v16
    v_fmac_f32 v18, v17, v17
    v_sub_f32 v17, v38, v16
    v_fmac_f32 v18, v17, v17
    v_sub_f32 v17, v39, v16
    v_fmac_f32 v18, v17, v17
    s_nop 1
    v_add_f32_dpp v18, v18, v18 quad_perm:[1,0,3,2] row_mask:0xf bank_mask:0xf
    s_nop 1
    v_add_f32_dpp v18, v18, v18 quad_perm:[2,3,0,1] row_mask:0xf bank_mask:0xf
    s_nop 1
    v_add_f32_dpp v18, v18, v18 row_half_mirror row_mask:0xf bank_mask:0xf
    s_nop 1
    v_add_f32_dpp v18, v18, v18 row_mirror row_mask:0xf bank_mask:0xf
    v_mov_b32 v17, v18
    s_nop 1
    v_permlane16_swap_b32 v18, v17
    s_nop 1
    v_add_f32 v18, v18, v17
    v_mov_b32 v17, v18
    s_nop 1
    v_permlane32_swap_b32 v18, v17
    s_nop 1
    v_add_f32 v18, v18, v17
    v_mul_f32 v18, 0x3b000000, v18
    v_cvt_pk_bf16_f32 v16, v16, v16
    v_and_b32 v16, s56, v16
    v_cvt_pk_bf16_f32 v18, v18, v18
    v_and_b32 v18, s56, v18
    v_add_f32 v18, 0x3727c5ac, v18
    v_cvt_pk_bf16_f32 v18, v18, v18
    v_and_b32 v18, s56, v18
    v_sqrt_f32 v18, v18
    s_nop 0
    v_cvt_pk_bf16_f32 v18, v18, v18
    v_and_b32 v18, s56, v18
    v_rcp_f32 v19, v18
    v_sub_f32 v32, v32, v16
    v_cvt_pk_bf16_f32 v32, v32, v32
    v_and_b32 v32, s56, v32
    v_mul_f32 v17, v32, v19
    v_fma_f32 v20, -v17, v18, v32
    v_fma_f32 v17, v20, v19, v17
    v_cvt_pk_bf16_f32 v32, v17, v17
    v_sub_f32 v33, v33, v16
    v_cvt_pk_bf16_f32 v33, v33, v33
    v_and_b32 v33, s56, v33
    v_mul_f32 v17, v33, v19
    v_fma_f32 v20, -v17, v18, v33
    v_fma_f32 v17, v20, v19, v17
    v_cvt_pk_bf16_f32 v33, v17, v17
    v_sub_f32 v34, v34, v16
    v_cvt_pk_bf16_f32 v34, v34, v34
    v_and_b32 v34, s56, v34
    v_mul_f32 v17, v34, v19
    v_fma_f32 v20, -v17, v18, v34
    v_fma_f32 v17, v20, v19, v17
    v_cvt_pk_bf16_f32 v34, v17, v17
    v_sub_f32 v35, v35, v16
    v_cvt_pk_bf16_f32 v35, v35, v35
    v_and_b32 v35, s56, v35
    v_mul_f32 v17, v35, v19
    v_fma_f32 v20, -v17, v18, v35
    v_fma_f32 v17, v20, v19, v17
    v_cvt_pk_bf16_f32 v35, v17, v17
    v_sub_f32 v36, v36, v16
    v_cvt_pk_bf16_f32 v36, v36, v36
    v_and_b32 v36, s56, v36
    v_mul_f32 v17, v36, v19
    v_fma_f32 v20, -v17, v18, v36
    v_fma_f32 v17, v20, v19, v17
    v_cvt_pk_bf16_f32 v36, v17, v17
    v_sub_f32 v37, v37, v16
    v_cvt_pk_bf16_f32 v37, v37, v37
    v_and_b32 v37, s56, v37
    v_mul_f32 v17, v37, v19
    v_fma_f32 v20, -v17, v18, v37
    v_fma_f32 v17, v20, v19, v17
    v_cvt_pk_bf16_f32 v37, v17, v17
    v_sub_f32 v38, v38, v16
    v_cvt_pk_bf16_f32 v38, v38, v38
    v_and_b32 v38, s56, v38
    v_mul_f32 v17, v38, v19
    v_fma_f32 v20, -v17, v18, v38
    v_fma_f32 v17, v20, v19, v17
    v_cvt_pk_bf16_f32 v38, v17, v17
    v_sub_f32 v39, v39, v16
    v_cvt_pk_bf16_f32 v39, v39, v39
    v_and_b32 v39, s56, v39
    v_mul_f32 v17, v39, v19
    v_fma_f32 v20, -v17, v18, v39
    v_fma_f32 v17, v20, v19, v17
    v_cvt_pk_bf16_f32 v39, v17, v17
    v_lshlrev_b32 v8, 5, v1
    ds_write_b128 v8, v[32:35] offset:0
    ds_write_b128 v8, v[36:39] offset:16
    s_lshl_b32 s57, s29, 8
    v_lshl_add_u32 v8, v52, 6, s57
    s_waitcnt lgkmcnt(0)
    ds_read_b128 v[24:27], v8 offset:0
    ds_read_b128 v[28:31], v8 offset:16
    ds_read_b128 v[32:35], v8 offset:32
    ds_read_b128 v[36:39], v8 offset:48
    s_mul_i32 s61, s61, 0x9e3779b1
    s_add_u32 s61, s61, 0x7f4a7c15
    s_mov_b32 s64, s61
    s_lshr_b32 s65, s61, 8
    s_lshr_b32 s66, s61, 16
    s_lshr_b32 s67, s61, 24
    v_mov_b32 v57, s55
    s_waitcnt lgkmcnt(0)
    s_waitcnt vmcnt(38)
    v_and_b32 v16, v24, v4
    v_and_b32 v17, v24, v5
    v_and_b32 v18, v24, v6
    v_and_b32 v19, v24, v7
    s_nop 1
    v_mfma_f32_16x16x32_bf16 v[8:11], v[16:19], v[64:67], 0
    s_waitcnt vmcnt(37)
    v_and_b32 v20, v25, v4
    v_and_b32 v21, v25, v5
    v_and_b32 v22, v25, v6
    v_and_b32 v23, v25, v7
    s_nop 1
    v_mfma_f32_16x16x32_bf16 v[8:11], v[20:23], v[68:71], v[8:11]
    s_waitcnt vmcnt(36)
    v_and_b32 v16, v26, v4
    v_and_b32 v17, v26, v5
    v_and_b32 v18, v26, v6
    v_and_b32 v19, v26, v7
    s_nop 1
    v_mfma_f32_16x16x32_bf16 v[8:11], v[16:19], v[72:75], v[8:11]
    s_waitcnt vmcnt(35)
    v_and_b32 v20, v27, v4
    v_and_b32 v21, v27, v5
    v_and_b32 v22, v27, v6
    v_and_b32 v23, v27, v7
    s_nop 1
    v_mfma_f32_16x16x32_bf16 v[8:11], v[20:23], v[76:79], v[8:11]
    s_waitcnt vmcnt(34)
    v_and_b32 v16, v28, v4
    v_and_b32 v17, v28, v5
    v_and_b32 v18, v28, v6
    v_and_b32 v19, v28, v7
    s_nop 1
    v_mfma_f32_16x16x32_bf16 v[8:11], v[16:19], v[80:83], v[8:11]
    s_waitcnt vmcnt(33)
    v_and_b32 v20, v29, v4
    v_and_b32 v21, v29, v5
    v_and_b32 v22, v29, v6
    v_and_b32 v23, v29, v7
    s_nop 1
    v_mfma_f32_16x16x32_bf16 v[8:11], v[20:23], v[84:87], v[8:11]
    s_waitcnt vmcnt(32)
    v_and_b32 v16, v30, v4
    v_and_b32 v17, v30, v5
    v_and_b32 v18, v30, v6
    v_and_b32 v19, v30, v7
    s_nop 1
    v_mfma_f32_16x16x32_bf16 v[8:11], v[16:19], v[88:91], v[8:11]
    s_waitcnt vmcnt(31)
    v_and_b32 v20, v31, v4
    v_and_b32 v21, v31, v5
    v_and_b32 v22, v31, v6
    v_and_b32 v23, v31, v7
    s_nop 1
    v_mfma_f32_16x16x32_bf16 v[8:11], v[20:23], v[92:95], v[8:11]
    s_waitcnt vmcnt(30)
    v_and_b32 v16, v32, v4
    v_and_b32 v17, v32, v5
    v_and_b32 v18, v32, v6
    v_and_b32 v19, v32, v7
    s_nop 1
    v_mfma_f32_16x16x32_bf16 v[8:11], v[16:19], v[96:99], v[8:11]
    s_waitcnt vmcnt(29)
    v_and_b32 v20, v33, v4
    v_and_b32 v21, v33, v5
    v_and_b32 v22, v33, v6
    v_and_b32 v23, v33, v7
    s_nop 1
    v_mfma_f32_16x16x32_bf16 v[8:11], v[20:23], v[100:103], v[8:11]
    s_waitcnt vmcnt(28)
    v_and_b32 v16, v34, v4
    v_and_b32 v17, v34, v5
    v_and_b32 v18, v34, v6
    v_and_b32 v19, v34, v7
    s_nop 1
    v_mfma_f32_16x16x32_bf16 v[8:11], v[16:19], v[104:107], v[8:11]
    s_waitcnt vmcnt(27)
    v_and_b32 v20, v35, v4
    v_and_b32 v21, v35, v5
    v_and_b32 v22, v35, v6
    v_and_b32 v23, v35, v7
    s_nop 1
    v_mfma_f32_16x16x32_bf16 v[8:11], v[20:23], v[108:111], v[8:11]
    s_waitcnt vmcnt(26)
    v_and_b32 v16, v36, v4
    v_and_b32 v17, v36, v5
    v_and_b32 v18, v36, v6
    v_and_b32 v19, v36, v7
    s_nop 1
    v_mfma_f32_16x16x32_bf16 v[8:11], v[16:19], v[112:115], v[8:11]
    s_waitcnt vmcnt(25)
    v_and_b32 v20, v37, v4
    v_and_b32 v21, v37, v5
    v_and_b32 v22, v37, v6
    v_and_b32 v23, v37, v7
    s_nop 1
    v_mfma_f32_16x16x32_bf16 v[8:11], v[20:23], v[116:119], v[8:11]
    s_waitcnt vmcnt(24)
    v_and_b32 v16, v38, v4
    v_and_b32 v17, v38, v5
    v_and_b32 v18, v38, v6
    v_and_b32 v19, v38, v7
    s_nop 1
    v_mfma_f32_16x16x32_bf16 v[8:11], v[16:19], v[120:123], v[8:11]
    s_waitcnt vmcnt(23)
    v_and_b32 v20, v39, v4
    v_and_b32 v21, v39, v5
    v_and_b32 v22, v39, v6
    v_and_b32 v23, v39, v7
    s_nop 1
    v_mfma_f32_16x16x32_bf16 v[8:11], v[20:23], v[124:127], v[8:11]
    s_lshl_b32 s57, s29, 8
    v_lshl_add_u32 v12, v40, 5, s57
    ds_read_b128 v[32:35], v12 offset:0
    ds_read_b128 v[36:39], v12 offset:16
    s_waitcnt lgkmcnt(0)
    s_waitcnt vmcnt(21)
    v_and_b32 v16, v32, v4
    v_and_b32 v17, v32, v5
    v_and_b32 v18, v32, v6
    v_and_b32 v19, v32, v7
    s_nop 1
    v_mfma_f32_16x16x32_bf16 v[24:27], v[16:19], v[192:195], 0
    v_mfma_f32_16x16x32_bf16 v[28:31], v[16:19], v[196:199], 0
    s_waitcnt vmcnt(19)
    v_and_b32 v20, v33, v4
    v_and_b32 v21, v33, v5
    v_and_b32 v22, v33, v6
    v_and_b32 v23, v33, v7
    s_nop 1
    v_mfma_f32_16x16x32_bf16 v[24:27], v[20:23], v[200:203], v[24:27]
    v_mfma_f32_16x16x32_bf16 v[28:31], v[20:23], v[204:207], v[28:31]
    s_waitcnt vmcnt(17)
    v_and_b32 v16, v34, v4
    v_and_b32 v17, v34, v5
    v_and_b32 v18, v34, v6
    v_and_b32 v19, v34, v7
    s_nop 1
    v_mfma_f32_16x16x32_bf16 v[24:27], v[16:19], v[208:211], v[24:27]
    v_mfma_f32_16x16x32_bf16 v[28:31], v[16:19], v[212:215], v[28:31]
    s_waitcnt vmcnt(15)
    v_and_b32 v20, v35, v4
    v_and_b32 v21, v35, v5
    v_and_b32 v22, v35, v6
    v_and_b32 v23, v35, v7
    s_nop 1
    v_mfma_f32_16x16x32_bf16 v[24:27], v[20:23], v[216:219], v[24:27]
    v_mfma_f32_16x16x32_bf16 v[28:31], v[20:23], v[220:223], v[28:31]
    s_waitcnt vmcnt(13)
    v_and_b32 v16, v36, v4
    v_and_b32 v17, v36, v5
    v_and_b32 v18, v36, v6
    v_and_b32 v19, v36, v7
    s_nop 1
    v_mfma_f32_16x16x32_bf16 v[24:27], v[16:19], v[224:227], v[24:27]
    v_mfma_f32_16x16x32_bf16 v[28:31], v[16:19], v[228:231], v[28:31]
    s_waitcnt vmcnt(11)
    v_and_b32 v20, v37, v4
    v_and_b32 v21, v37, v5
    v_and_b32 v22, v37, v6
    v_and_b32 v23, v37, v7
    s_nop 1
    v_mfma_f32_16x16x32_bf16 v[24:27], v[20:23], v[232:235], v[24:27]
    v_mfma_f32_16x16x32_bf16 v[28:31], v[20:23], v[236:239], v[28:31]
    s_waitcnt vmcnt(9)
    v_and_b32 v16, v38, v4
    v_and_b32 v17, v38, v5
    v_and_b32 v18, v38, v6
    v_and_b32 v19, v38, v7
    s_nop 1
    v_mfma_f32_16x16x32_bf16 v[24:27], v[16:19], v[240:243], v[24:27]
    v_mfma_f32_16x16x32_bf16 v[28:31], v[16:19], v[244:247], v[28:31]
    s_waitcnt vmcnt(7)
    v_and_b32 v20, v39, v4
    v_and_b32 v21, v39, v5
    v_and_b32 v22, v39, v6
    v_and_b32 v23, v39, v7
    s_nop 1
    v_mfma_f32_16x16x32_bf16 v[24:27], v[20:23], v[248:251], v[24:27]
    v_mfma_f32_16x16x32_bf16 v[28:31], v[20:23], v[252:255], v[28:31]
    s_nop 7
    v_mov_b32_dpp v16, v24 row_ror:8 row_mask:0xf bank_mask:0xf
    v_mov_b32_dpp v17, v25 row_ror:8 row_mask:0xf bank_mask:0xf
    v_mov_b32_dpp v18, v26 row_ror:8 row_mask:0xf bank_mask:0xf
    v_mov_b32_dpp v19, v27 row_ror:8 row_mask:0xf bank_mask:0xf
    s_nop 1
    v_permlane32_swap_b32 v16, v20
    v_permlane32_swap_b32 v17, v21
    v_permlane32_swap_b32 v18, v22
    v_permlane32_swap_b32 v19, v23
    s_nop 1
    v_add_f32 v24, v24, v20
    v_add_f32 v25, v25, v21
    v_add_f32 v26, v26, v22
    v_add_f32 v27, v27, v23
    v_mov_b32_dpp v16, v28 row_ror:8 row_mask:0xf bank_mask:0xf
    v_mov_b32_dpp v17, v29 row_ror:8 row_mask:0xf bank_mask:0xf
    v_mov_b32_dpp v18, v30 row_ror:8 row_mask:0xf bank_mask:0xf
    v_mov_b32_dpp v19, v31 row_ror:8 row_mask:0xf bank_mask:0xf
    s_nop 1
    v_permlane32_swap_b32 v16, v20
    v_permlane32_swap_b32 v17, v21
    v_permlane32_swap_b32 v18, v22
    v_permlane32_swap_b32 v19, v23
    s_nop 1
    v_add_f32 v28, v28, v20
    v_add_f32 v29, v29, v21
    v_add_f32 v30, v30, v22
    v_add_f32 v31, v31, v23
    v_mov_b32_dpp v24, v28 row_ror:8 row_mask:0xf bank_mask:0xc
    v_mov_b32_dpp v25, v29 row_ror:8 row_mask:0xf bank_mask:0xc
    v_mov_b32_dpp v26, v30 row_ror:8 row_mask:0xf bank_mask:0xc
    v_mov_b32_dpp v27, v31 row_ror:8 row_mask:0xf bank_mask:0xc
    v_mov_b32_dpp v24, v8 quad_perm:[0,1,2,3] row_mask:0xc bank_mask:0xf
    v_mov_b32_dpp v25, v9 quad_perm:[0,1,2,3] row_mask:0xc bank_mask:0xf
    v_mov_b32_dpp v26, v10 quad_perm:[0,1,2,3] row_mask:0xc bank_mask:0xf
    v_mov_b32_dpp v27, v11 quad_perm:[0,1,2,3] row_mask:0xc bank_mask:0xf
    v_bfi_b32 v24, v57, v24, s64
    v_bfi_b32 v25, v57, v25, s65
    v_bfi_b32 v26, v57, v26, s66
    v_bfi_b32 v27, v57, v27, s67
    s_waitcnt vmcnt(0)
    global_store_dwordx4 v55, v[24:27], s[26:27] sc1
    v_lshl_add_u32 v46, v40, 12, v42
    s_mov_b32 s57, 0
    buffer_load_dwordx4 v[192:195], v46, s[36:39], s57 offen offset:0 nt
    s_waitcnt vmcnt(0)
    s_mov_b32 s60, 300000
L_qpoll_parallel_sum__mha_block_:
    global_load_dwordx4 v[64:67], v56, s[26:27] offset:0 sc1
    global_load_dwordx4 v[68:71], v56, s[26:27] offset:1024 sc1
    global_load_dwordx4 v[72:75], v56, s[26:27] offset:2048 sc1
    global_load_dwordx4 v[76:79], v56, s[26:27] offset:3072 sc1
    global_load_dwordx4 v[80:83], v60, s[26:27] offset:0 sc1
    global_load_dwordx4 v[84:87], v60, s[26:27] offset:1024 sc1
    global_load_dwordx4 v[88:91], v60, s[26:27] offset:2048 sc1
    global_load_dwordx4 v[92:95], v60, s[26:27] offset:3072 sc1
    s_waitcnt vmcnt(0)
    v_xor_b32 v16, s64, v64
    v_bitop3_b32 v16, v16, v65, s65 bitop3:0xf6
    v_bitop3_b32 v16, v16, v66, s66 bitop3:0xf6
    v_bitop3_b32 v16, v16, v67, s67 bitop3:0xf6
    v_bitop3_b32 v16, v16, v68, s64 bitop3:0xf6
    v_bitop3_b32 v16, v16, v69, s65 bitop3:0xf6
    v_bitop3_b32 v16, v16, v70, s66 bitop3:0xf6
    v_bitop3_b32 v16, v16, v71, s67 bitop3:0xf6
    v_bitop3_b32 v16, v16, v72, s64 bitop3:0xf6
    v_bitop3_b32 v16, v16, v73, s65 bitop3:0xf6
    v_bitop3_b32 v16, v16, v74, s66 bitop3:0xf6
    v_bitop3_b32 v16, v16, v75, s67 bitop3:0xf6
    v_bitop3_b32 v16, v16, v76, s64 bitop3:0xf6
    v_bitop3_b32 v16, v16, v77, s65 bitop3:0xf6
    v_bitop3_b32 v16, v16, v78, s66 bitop3:0xf6
    v_bitop3_b32 v16, v16, v79, s67 bitop3:0xf6
    v_bitop3_b32 v16, v16, v80, s64 bitop3:0xf6
    v_bitop3_b32 v16, v16, v81, s65 bitop3:0xf6
    v_bitop3_b32 v16, v16, v82, s66 bitop3:0xf6
    v_bitop3_b32 v16, v16, v83, s67 bitop3:0xf6
    v_bitop3_b32 v16, v16, v84, s64 bitop3:0xf6
    v_bitop3_b32 v16, v16, v85, s65 bitop3:0xf6
    v_bitop3_b32 v16, v16, v86, s66 bitop3:0xf6
    v_bitop3_b32 v16, v16, v87, s67 bitop3:0xf6
    v_bitop3_b32 v16, v16, v88, s64 bitop3:0xf6
    v_bitop3_b32 v16, v16, v89, s65 bitop3:0xf6
    v_bitop3_b32 v16, v16, v90, s66 bitop3:0xf6
    v_bitop3_b32 v16, v16, v91, s67 bitop3:0xf6
    v_bitop3_b32 v16, v16, v92, s64 bitop3:0xf6
    v_bitop3_b32 v16, v16, v93, s65 bitop3:0xf6
    v_bitop3_b32 v16, v16, v94, s66 bitop3:0xf6
    v_bitop3_b32 v16, v16, v95, s67 bitop3:0xf6
    v_and_b32 v16, 31, v16
    v_cmp_ne_u32 vcc, 0, v16
    s_cbranch_vccz L_qgo_parallel_sum__mha_block_
    s_sub_u32 s60, s60, 1
    s_cmp_lg_u32 s60, 0
    s_cbranch_scc1 L_qpoll_parallel_sum__mha_block_
L_qgo_parallel_sum__mha_block_:
    v_and_b32 v64, s55, v64
    v_and_b32 v65, s55, v65
    v_and_b32 v66, s55, v66
    v_and_b32 v67, s55, v67
    v_and_b32 v68, s55, v68
    v_and_b32 v69, s55, v69
    v_and_b32 v70, s55, v70
    v_and_b32 v71, s55, v71
    v_and_b32 v72, s55, v72
    v_and_b32 v73, s55, v73
    v_and_b32 v74, s55, v74
    v_and_b32 v75, s55, v75
    v_and_b32 v76, s55, v76
    v_and_b32 v77, s55, v77
    v_and_b32 v78, s55, v78
    v_and_b32 v79, s55, v79
    v_and_b32 v80, s55, v80
    v_and_b32 v81, s55, v81
    v_and_b32 v82, s55, v82
    v_and_b32 v83, s55, v83
    v_and_b32 v84, s55, v84
    v_and_b32 v85, s55, v85
    v_and_b32 v86, s55, v86
    v_and_b32 v87, s55, v87
    v_and_b32 v88, s55, v88
    v_and_b32 v89, s55, v89
    v_and_b32 v90, s55, v90
    v_and_b32 v91, s55, v91
    v_and_b32 v92, s55, v92
    v_and_b32 v93, s55, v93
    v_and_b32 v94, s55, v94
    v_and_b32 v95, s55, v95
    v_add_f32 v64, v64, v68
    v_add_f32 v65, v65, v69
    v_add_f32 v66, v66, v70
    v_add_f32 v67, v67, v71
    v_add_f32 v72, v72, v76
    v_add_f32 v73, v73, v77
    v_add_f32 v74, v74, v78
    v_add_f32 v75, v75, v79
    v_add_f32 v80, v80, v84
    v_add_f32 v81, v81, v85
    v_add_f32 v82, v82, v86
    v_add_f32 v83, v83, v87
    v_add_f32 v88, v88, v92
    v_add_f32 v89, v89, v93
    v_add_f32 v90, v90, v94
    v_add_f32 v91, v91, v95
    v_add_f32 v64, v64, v72
    v_add_f32 v65, v65, v73
    v_add_f32 v66, v66, v74
    v_add_f32 v67, v67, v75
    v_add_f32 v80, v80, v88
    v_add_f32 v81, v81, v89
    v_add_f32 v82, v82, v90
    v_add_f32 v83, v83, v91
    v_add_f32 v64, v64, v80
    v_add_f32 v65, v65, v81
    v_add_f32 v66, v66, v82
    v_add_f32 v67, v67, v83
    v_cvt_pk_bf16_f32 v68, v64, v65
    v_cvt_pk_bf16_f32 v69, v66, v67
    s_mov_b32 exec_lo, 0
    ds_write_b64 v54, v[68:69] offset:2048
    s_mov_b32 exec_lo, -1
    v_mov_b32 v58, 1
    s_waitcnt lgkmcnt(0)
    ds_write_b32 v59, v58 offset:4644
    v_cvt_pk_bf16_f32 v64, v64, v64
    v_and_b32 v64, s56, v64
    v_cvt_pk_bf16_f32 v65, v65, v65
    v_and_b32 v65, s56, v65
    v_cvt_pk_bf16_f32 v66, v66, v66
    v_and_b32 v66, s56, v66
    v_cvt_pk_bf16_f32 v67, v67, v67
    v_and_b32 v67, s56, v67
    v_mov_b32 v68, v64
    v_mov_b32 v69, v65
    v_mov_b32 v70, v66
    v_mov_b32 v71, v67
    v_permlane16_swap_b32 v64, v68
    v_permlane16_swap_b32 v65, v69
    v_permlane16_swap_b32 v66, v70
    v_permlane16_swap_b32 v67, v71
    v_cmp_lt_f32 vcc, 0, v64
    s_nop 1
    v_cndmask_b32 v16, 0, 1.0, vcc
    v_mul_f32 v64, v64, v16
    v_mul_f32 v64, v64, v68
    v_cvt_pk_bf16_f32 v64, v64, v64
    v_cmp_lt_f32 vcc, 0, v65
    s_nop 1
    v_cndmask_b32 v16, 0, 1.0, vcc
    v_mul_f32 v65, v65, v16
    v_mul_f32 v65, v65, v69
    v_cvt_pk_bf16_f32 v65, v65, v65
    v_cmp_lt_f32 vcc, 0, v66
    s_nop 1
    v_cndmask_b32 v16, 0, 1.0, vcc
    v_mul_f32 v66, v66, v16
    v_mul_f32 v66, v66, v70
    v_cvt_pk_bf16_f32 v66, v66, v66
    v_cmp_lt_f32 vcc, 0, v67
    s_nop 1
    v_cndmask_b32 v16, 0, 1.0, vcc
    v_mul_f32 v67, v67, v16
    v_mul_f32 v67, v67, v71
    v_cvt_pk_bf16_f32 v67, v67, v67
    v_lshlrev_b32 v17, 4, v53
    s_mov_b32 exec_hi, 0
    ds_write_b128 v17, v[64:67] offset:2304
    s_mov_b32 exec_hi, -1
    v_lshlrev_b32 v16, 2, v40
    s_waitcnt lgkmcnt(0)
    ds_read_b32 v24, v16 offset:2304
    ds_read_b32 v25, v16 offset:2336
    ds_read_b32 v26, v16 offset:2368
    ds_read_b32 v27, v16 offset:2400
    ds_read_b32 v28, v16 offset:2432
    ds_read_b32 v29, v16 offset:2464
    ds_read_b32 v30, v16 offset:2496
    s_waitcnt lgkmcnt(0)
    v_and_b32 v16, v24, v4
    v_and_b32 v17, v24, v5
    v_and_b32 v18, v24, v6
    v_and_b32 v19, v24, v7
    s_nop 1
    v_mfma_f32_16x16x32_bf16 v[8:11], v[16:19], v[128:131], 0
    v_and_b32 v20, v25, v4
    v_and_b32 v21, v25, v5
    v_and_b32 v22, v25, v6
    v_and_b32 v23, v25, v7
    s_nop 1
    v_mfma_f32_16x16x32_bf16 v[8:11], v[20:23], v[132:135], v[8:11]
    v_and_b32 v16, v26, v4
    v_and_b32 v17, v26, v5
    v_and_b32 v18, v26, v6
    v_and_b32 v19, v26, v7
    s_nop 1
    v_mfma_f32_16x16x32_bf16 v[8:11], v[16:19], v[136:139], v[8:11]
    v_and_b32 v20, v27, v4
    v_and_b32 v21, v27, v5
    v_and_b32 v22, v27, v6
    v_and_b32 v23, v27, v7
    s_nop 1
    v_mfma_f32_16x16x32_bf16 v[8:11], v[20:23], v[140:143], v[8:11]
    v_and_b32 v16, v28, v4
    v_and_b32 v17, v28, v5
    v_and_b32 v18, v28, v6
    v_and_b32 v19, v28, v7
    s_nop 1
    v_mfma_f32_16x16x32_bf16 v[8:11], v[16:19], v[144:147], v[8:11]
    v_and_b32 v20, v29, v4
    v_and_b32 v21, v29, v5
    v_and_b32 v22, v29, v6
    v_and_b32 v23, v29, v7
    s_nop 1
    v_mfma_f32_16x16x32_bf16 v[8:11], v[20:23], v[148:151], v[8:11]
    v_and_b32 v16, v30, v4
    v_and_b32 v17, v30, v5
    v_and_b32 v18, v30, v6
    v_and_b32 v19, v30, v7
    s_nop 1
    v_mfma_f32_16x16x32_bf16 v[8:11], v[16:19], v[152:155], v[8:11]
    v_add_u32 v45, 65536, v44
    s_nop 7
    v_mov_b32_dpp v16, v8 row_ror:8 row_mask:0xf bank_mask:0xf
    v_mov_b32_dpp v17, v9 row_ror:8 row_mask:0xf bank_mask:0xf
    v_mov_b32_dpp v18, v10 row_ror:8 row_mask:0xf bank_mask:0xf
    v_mov_b32_dpp v19, v11 row_ror:8 row_mask:0xf bank_mask:0xf
    s_nop 1
    v_permlane32_swap_b32 v16, v20
    v_permlane32_swap_b32 v17, v21
    v_permlane32_swap_b32 v18, v22
    v_permlane32_swap_b32 v19, v23
    s_nop 1
    v_add_f32 v8, v8, v20
    v_add_f32 v9, v9, v21
    v_add_f32 v10, v10, v22
    v_add_f32 v11, v11, v23
    v_bfi_b32 v8, v57, v8, s64
    v_bfi_b32 v9, v57, v9, s65
    v_bfi_b32 v10, v57, v10, s66
    v_bfi_b32 v11, v57, v11, s67
    s_mov_b64 exec, 0x00ff00ff
    global_store_dwordx4 v45, v[8:11], s[26:27] sc1
    s_mov_b64 exec, -1
    s_lshl_b32 s57, s29, 2
    s_cmp_lg_u32 s57, s28
    s_cbranch_scc1 L_nob_parallel_sum__mha_block_
    s_lshl_b32 s57, s29, 13
    s_add_u32 s57, s57, 589824
    v_add_u32 v16, s57, v3
    v_add_u32 v17, 0x1000, v16
    s_mov_b32 s60, 300000
L_bpoll_parallel_sum__mha_block_:
    s_sleep 127
    global_load_dwordx4 v[64:67], v16, s[26:27] offset:0 sc1
    global_load_dwordx4 v[68:71], v16, s[26:27] offset:1024 sc1
    global_load_dwordx4 v[72:75], v16, s[26:27] offset:2048 sc1
    global_load_dwordx4 v[76:79], v16, s[26:27] offset:3072 sc1
    global_load_dwordx4 v[80:83], v17, s[26:27] offset:0 sc1
    global_load_dwordx4 v[84:87], v17, s[26:27] offset:1024 sc1
    global_load_dwordx4 v[88:91], v17, s[26:27] offset:2048 sc1
    global_load_dwordx4 v[92:95], v17, s[26:27] offset:3072 sc1
    s_waitcnt vmcnt(0)
    v_xor_b32 v20, s64, v64
    v_bitop3_b32 v20, v20, v65, s65 bitop3:0xf6
    v_bitop3_b32 v20, v20, v66, s66 bitop3:0xf6
    v_bitop3_b32 v20, v20, v67, s67 bitop3:0xf6
    v_bitop3_b32 v20, v20, v68, s64 bitop3:0xf6
    v_bitop3_b32 v20, v20, v69, s65 bitop3:0xf6
    v_bitop3_b32 v20, v20, v70, s66 bitop3:0xf6
    v_bitop3_b32 v20, v20, v71, s67 bitop3:0xf6
    v_bitop3_b32 v20, v20, v72, s64 bitop3:0xf6
    v_bitop3_b32 v20, v20, v73, s65 bitop3:0xf6
    v_bitop3_b32 v20, v20, v74, s66 bitop3:0xf6
    v_bitop3_b32 v20, v20, v75, s67 bitop3:0xf6
    v_bitop3_b32 v20, v20, v76, s64 bitop3:0xf6
    v_bitop3_b32 v20, v20, v77, s65 bitop3:0xf6
    v_bitop3_b32 v20, v20, v78, s66 bitop3:0xf6
    v_bitop3_b32 v20, v20, v79, s67 bitop3:0xf6
    v_bitop3_b32 v20, v20, v80, s64 bitop3:0xf6
    v_bitop3_b32 v20, v20, v81, s65 bitop3:0xf6
    v_bitop3_b32 v20, v20, v82, s66 bitop3:0xf6
    v_bitop3_b32 v20, v20, v83, s67 bitop3:0xf6
    v_bitop3_b32 v20, v20, v84, s64 bitop3:0xf6
    v_bitop3_b32 v20, v20, v85, s65 bitop3:0xf6
    v_bitop3_b32 v20, v20, v86, s66 bitop3:0xf6
    v_bitop3_b32 v20, v20, v87, s67 bitop3:0xf6
    v_bitop3_b32 v20, v20, v88, s64 bitop3:0xf6
    v_bitop3_b32 v20, v20, v89, s65 bitop3:0xf6
    v_bitop3_b32 v20, v20, v90, s66 bitop3:0xf6
    v_bitop3_b32 v20, v20, v91, s67 bitop3:0xf6
    v_bitop3_b32 v20, v20, v92, s64 bitop3:0xf6
    v_bitop3_b32 v20, v20, v93, s65 bitop3:0xf6
    v_bitop3_b32 v20, v20, v94, s66 bitop3:0xf6
    v_bitop3_b32 v20, v20, v95, s67 bitop3:0xf6
    v_and_b32 v20, 31, v20
    v_cmp_ne_u32 vcc, 0, v20
    s_cbranch_vccz L_bgo_parallel_sum__mha_block_
    s_sub_u32 s60, s60, 1
    s_cmp_lg_u32 s60, 0
    s_cbranch_scc1 L_bpoll_parallel_sum__mha_block_
L_bgo_parallel_sum__mha_block_:
    v_and_b32 v64, s55, v64
    v_and_b32 v65, s55, v65
    v_and_b32 v66, s55, v66
    v_and_b32 v67, s55, v67
    v_and_b32 v68, s55, v68
    v_and_b32 v69, s55, v69
    v_and_b32 v70, s55, v70
    v_and_b32 v71, s55, v71
    v_and_b32 v72, s55, v72
    v_and_b32 v73, s55, v73
    v_and_b32 v74, s55, v74
    v_and_b32 v75, s55, v75
    v_and_b32 v76, s55, v76
    v_and_b32 v77, s55, v77
    v_and_b32 v78, s55, v78
    v_and_b32 v79, s55, v79
    v_and_b32 v80, s55, v80
    v_and_b32 v81, s55, v81
    v_and_b32 v82, s55, v82
    v_and_b32 v83, s55, v83
    v_and_b32 v84, s55, v84
    v_and_b32 v85, s55, v85
    v_and_b32 v86, s55, v86
    v_and_b32 v87, s55, v87
    v_and_b32 v88, s55, v88
    v_and_b32 v89, s55, v89
    v_and_b32 v90, s55, v90
    v_and_b32 v91, s55, v91
    v_and_b32 v92, s55, v92
    v_and_b32 v93, s55, v93
    v_and_b32 v94, s55, v94
    v_and_b32 v95, s55, v95
    v_add_f32 v64, v64, v68
    v_add_f32 v65, v65, v69
    v_add_f32 v66, v66, v70
    v_add_f32 v67, v67, v71
    v_add_f32 v72, v72, v76
    v_add_f32 v73, v73, v77
    v_add_f32 v74, v74, v78
    v_add_f32 v75, v75, v79
    v_add_f32 v80, v80, v84
    v_add_f32 v81, v81, v85
    v_add_f32 v82, v82, v86
    v_add_f32 v83, v83, v87
    v_add_f32 v88, v88, v92
    v_add_f32 v89, v89, v93
    v_add_f32 v90, v90, v94
    v_add_f32 v91, v91, v95
    v_add_f32 v64, v64, v72
    v_add_f32 v65, v65, v73
    v_add_f32 v66, v66, v74
    v_add_f32 v67, v67, v75
    v_add_f32 v80, v80, v88
    v_add_f32 v81, v81, v89
    v_add_f32 v82, v82, v90
    v_add_f32 v83, v83, v91
    v_add_f32 v64, v64, v80
    v_add_f32 v65, v65, v81
    v_add_f32 v66, v66, v82
    v_add_f32 v67, v67, v83
    v_mov_b32 v68, v64
    v_mov_b32 v69, v65
    v_mov_b32 v70, v66
    v_mov_b32 v71, v67
    v_permlane16_swap_b32 v64, v68
    v_permlane16_swap_b32 v65, v69
    v_permlane16_swap_b32 v66, v70
    v_permlane16_swap_b32 v67, v71
    v_add_f32 v64, v64, v68
    v_add_f32 v65, v65, v69
    v_add_f32 v66, v66, v70
    v_add_f32 v67, v67, v71
    v_mov_b32 v68, v64
    v_mov_b32 v69, v65
    v_mov_b32 v70, v66
    v_mov_b32 v71, v67
    v_permlane32_swap_b32 v64, v68
    v_permlane32_swap_b32 v65, v69
    v_permlane32_swap_b32 v66, v70
    v_permlane32_swap_b32 v67, v71
    v_add_f32 v64, v64, v68
    v_add_f32 v65, v65, v69
    v_add_f32 v66, v66, v70
    v_add_f32 v67, v67, v71
    v_cvt_pk_bf16_f32 v64, v64, v64
    v_cvt_pk_bf16_f32 v65, v65, v65
    v_cvt_pk_bf16_f32 v66, v66, v66
    v_cvt_pk_bf16_f32 v67, v67, v67
    v_and_b32 v64, s56, v64
    v_and_b32 v65, s56, v65
    v_and_b32 v66, s56, v66
    v_and_b32 v67, s56, v67
    v_lshlrev_b32 v16, 4, v53
    ds_write_b128 v16, v[64:67] offset:4672
L_nob_parallel_sum__mha_block_:
    v_lshlrev_b32 v49, 4, v40
    v_lshlrev_b32 v50, 10, v41
    v_add_u32 v50, s62, v50
    v_add_u32 v51, v49, v50
    v_cmp_eq_u32 s[74:75], 32, v1
    v_cmp_eq_u32 s[70:71], s29, v41
    s_waitcnt vmcnt(0) lgkmcnt(0)
    s_mov_b32 s60, 4800000
L_lw_parallel_sum__mha_block_:
    s_sleep 1
    ds_read_b32 v16, v59 offset:4648
    s_waitcnt lgkmcnt(0)
    v_cmp_ne_u32 vcc, 0, v16
    s_cbranch_vccz L_lg_parallel_sum__mha_block_
    s_sub_u32 s60, s60, 1
    s_cmp_lg_u32 s60, 0
    s_cbranch_scc1 L_lw_parallel_sum__mha_block_
L_lg_parallel_sum__mha_block_:
    s_mov_b32 s57, 0
    buffer_load_dwordx4 v[196:199], v46, s[36:39], s57 offen offset:1024 nt
    buffer_load_dwordx4 v[200:203], v46, s[36:39], s57 offen offset:2048 nt
    buffer_load_dwordx4 v[204:207], v46, s[36:39], s57 offen offset:3072 nt
    s_mov_b32 s57, 32768
    buffer_load_dwordx4 v[208:211], v46, s[36:39], s57 offen offset:0 nt
    buffer_load_dwordx4 v[212:215], v46, s[36:39], s57 offen offset:1024 nt
    buffer_load_dwordx4 v[216:219], v46, s[36:39], s57 offen offset:2048 nt
    buffer_load_dwordx4 v[220:223], v46, s[36:39], s57 offen offset:3072 nt
    s_mov_b32 s57, 65536
    buffer_load_dwordx4 v[224:227], v46, s[36:39], s57 offen offset:0 nt
    buffer_load_dwordx4 v[228:231], v46, s[36:39], s57 offen offset:1024 nt
    buffer_load_dwordx4 v[232:235], v46, s[36:39], s57 offen offset:2048 nt
    buffer_load_dwordx4 v[236:239], v46, s[36:39], s57 offen offset:3072 nt
    s_mov_b32 s57, 98304
    buffer_load_dwordx4 v[240:243], v46, s[36:39], s57 offen offset:0 nt
    buffer_load_dwordx4 v[244:247], v46, s[36:39], s57 offen offset:1024 nt
    buffer_load_dwordx4 v[248:251], v46, s[36:39], s57 offen offset:2048 nt
    buffer_load_dwordx4 v[252:255], v46, s[36:39], s57 offen offset:3072 nt
    s_mov_b32 s60, 300000
    s_barrier
    ds_read_b64 v[80:81], v59 offset:4608
    ds_read_b64 v[84:85], v59 offset:4624
    ds_read_b128 v[64:67], v48 offset:2560
    ds_read_b128 v[68:71], v48 offset:3072
    s_not_b64 s[76:77], s[70:71]
    s_waitcnt lgkmcnt(3)
    v_max_f32 v16, v80, v81
    v_sub_f32 v80, v80, v16
    v_sub_f32 v81, v81, v16
    v_mul_f32 v80, s31, v80
    v_mul_f32 v81, s31, v81
    v_exp_f32 v80, v80
    v_exp_f32 v81, v81
    s_waitcnt lgkmcnt(0)
    v_mul_f32 v8, v64, v80
    v_mul_f32 v9, v65, v80
    v_mul_f32 v10, v66, v80
    v_mul_f32 v11, v67, v80
    v_mul_f32 v17, v84, v80
    v_fmac_f32 v8, v68, v81
    v_fmac_f32 v9, v69, v81
    v_fmac_f32 v10, v70, v81
    v_fmac_f32 v11, v71, v81
    v_fmac_f32 v17, v85, v81
    v_cndmask_b32 v8, v8, v16, s[74:75]
    v_cndmask_b32 v9, v9, v17, s[74:75]
    v_bfi_b32 v12, v57, v8, s64
    v_bfi_b32 v13, v57, v9, s65
    v_bfi_b32 v14, v57, v10, s66
    v_bfi_b32 v15, v57, v11, s67
    s_mov_b32 exec_hi, 1
    global_store_dwordx4 v43, v[12:15], s[26:27] sc1
    s_mov_b64 exec, s[76:77]
    global_load_dwordx4 v[132:135], v51, s[26:27] offset:0 sc1
    global_load_dwordx4 v[136:139], v51, s[26:27] offset:128 sc1
    global_load_dwordx4 v[140:143], v51, s[26:27] offset:256 sc1
    global_load_dwordx4 v[144:147], v51, s[26:27] offset:384 sc1
    global_load_dwordx2 v[148:149], v50, s[26:27] offset:512 sc1
    s_mov_b32 exec_lo, -1
    s_mov_b32 exec_hi, 1
    v_and_b32 v8, s55, v8
    v_and_b32 v9, s55, v9
    v_and_b32 v10, s55, v10
    v_and_b32 v11, s55, v11
    ds_write_b128 v3, v[8:11] offset:4928
    s_mov_b64 exec, s[70:71]
    s_waitcnt lgkmcnt(0)
    ds_read_b128 v[64:67], v49 offset:4928
    ds_read_b128 v[68:71], v49 offset:5056
    ds_read_b128 v[72:75], v49 offset:5184
    ds_read_b128 v[76:79], v49 offset:5312
    ds_read_b64 v[80:81], v59 offset:5440
    s_mov_b64 exec, s[76:77]
    global_load_dwordx4 v[152:155], v51, s[26:27] offset:0 sc1
    global_load_dwordx4 v[156:159], v51, s[26:27] offset:128 sc1
    global_load_dwordx4 v[160:163], v51, s[26:27] offset:256 sc1
    global_load_dwordx4 v[164:167], v51, s[26:27] offset:384 sc1
    global_load_dwordx2 v[168:169], v50, s[26:27] offset:512 sc1
    s_waitcnt vmcnt(5) lgkmcnt(0)
    v_xor_b32 v16, s64, v132
    v_bitop3_b32 v16, v16, v133, s65 bitop3:0xf6
    v_bitop3_b32 v16, v16, v134, s66 bitop3:0xf6
    v_bitop3_b32 v16, v16, v135, s67 bitop3:0xf6
    v_bitop3_b32 v16, v16, v136, s64 bitop3:0xf6
    v_bitop3_b32 v16, v16, v137, s65 bitop3:0xf6
    v_bitop3_b32 v16, v16, v138, s66 bitop3:0xf6
    v_bitop3_b32 v16, v16, v139, s67 bitop3:0xf6
    v_bitop3_b32 v16, v16, v140, s64 bitop3:0xf6
    v_bitop3_b32 v16, v16, v141, s65 bitop3:0xf6
    v_bitop3_b32 v16, v16, v142, s66 bitop3:0xf6
    v_bitop3_b32 v16, v16, v143, s67 bitop3:0xf6
    v_bitop3_b32 v16, v16, v144, s64 bitop3:0xf6
    v_bitop3_b32 v16, v16, v145, s65 bitop3:0xf6
    v_bitop3_b32 v16, v16, v146, s66 bitop3:0xf6
    v_bitop3_b32 v16, v16, v147, s67 bitop3:0xf6
    v_bitop3_b32 v16, v16, v148, s64 bitop3:0xf6
    v_bitop3_b32 v16, v16, v149, s65 bitop3:0xf6
    v_and_b32 v16, 31, v16
    v_cmp_eq_u32 vcc, 0, v16
    s_mov_b64 exec, vcc
    v_and_b32 v64, s55, v132
    v_and_b32 v65, s55, v133
    v_and_b32 v66, s55, v134
    v_and_b32 v67, s55, v135
    v_and_b32 v68, s55, v136
    v_and_b32 v69, s55, v137
    v_and_b32 v70, s55, v138
    v_and_b32 v71, s55, v139
    v_and_b32 v72, s55, v140
    v_and_b32 v73, s55, v141
    v_and_b32 v74, s55, v142
    v_and_b32 v75, s55, v143
    v_and_b32 v76, s55, v144
    v_and_b32 v77, s55, v145
    v_and_b32 v78, s55, v146
    v_and_b32 v79, s55, v147
    v_and_b32 v80, s55, v148
    v_and_b32 v81, s55, v149
    s_andn2_b64 s[76:77], s[76:77], vcc
    s_cbranch_scc0 L_ggo_parallel_sum__mha_block_
    s_mov_b64 exec, s[76:77]
    global_load_dwordx4 v[132:135], v51, s[26:27] offset:0 sc1
    global_load_dwordx4 v[136:139], v51, s[26:27] offset:128 sc1
    global_load_dwordx4 v[140:143], v51, s[26:27] offset:256 sc1
    global_load_dwordx4 v[144:147], v51, s[26:27] offset:384 sc1
    global_load_dwordx2 v[148:149], v50, s[26:27] offset:512 sc1
L_gpoll_parallel_sum__mha_block_:
    s_waitcnt vmcnt(5) lgkmcnt(0)
    v_xor_b32 v16, s64, v152
    v_bitop3_b32 v16, v16, v153, s65 bitop3:0xf6
    v_bitop3_b32 v16, v16, v154, s66 bitop3:0xf6
    v_bitop3_b32 v16, v16, v155, s67 bitop3:0xf6
    v_bitop3_b32 v16, v16, v156, s64 bitop3:0xf6
    v_bitop3_b32 v16, v16, v157, s65 bitop3:0xf6
    v_bitop3_b32 v16, v16, v158, s66 bitop3:0xf6
    v_bitop3_b32 v16, v16, v159, s67 bitop3:0xf6
    v_bitop3_b32 v16, v16, v160, s64 bitop3:0xf6
    v_bitop3_b32 v16, v16, v161, s65 bitop3:0xf6
    v_bitop3_b32 v16, v16, v162, s66 bitop3:0xf6
    v_bitop3_b32 v16, v16, v163, s67 bitop3:0xf6
    v_bitop3_b32 v16, v16, v164, s64 bitop3:0xf6
    v_bitop3_b32 v16, v16, v165, s65 bitop3:0xf6
    v_bitop3_b32 v16, v16, v166, s66 bitop3:0xf6
    v_bitop3_b32 v16, v16, v167, s67 bitop3:0xf6
    v_bitop3_b32 v16, v16, v168, s64 bitop3:0xf6
    v_bitop3_b32 v16, v16, v169, s65 bitop3:0xf6
    v_and_b32 v16, 31, v16
    v_cmp_eq_u32 vcc, 0, v16
    s_mov_b64 exec, vcc
    v_and_b32 v64, s55, v152
    v_and_b32 v65, s55, v153
    v_and_b32 v66, s55, v154
    v_and_b32 v67, s55, v155
    v_and_b32 v68, s55, v156
    v_and_b32 v69, s55, v157
    v_and_b32 v70, s55, v158
    v_and_b32 v71, s55, v159
    v_and_b32 v72, s55, v160
    v_and_b32 v73, s55, v161
    v_and_b32 v74, s55, v162
    v_and_b32 v75, s55, v163
    v_and_b32 v76, s55, v164
    v_and_b32 v77, s55, v165
    v_and_b32 v78, s55, v166
    v_and_b32 v79, s55, v167
    v_and_b32 v80, s55, v168
    v_and_b32 v81, s55, v169
    s_andn2_b64 s[76:77], s[76:77], vcc
    s_cbranch_scc0 L_ggo_parallel_sum__mha_block_
    s_mov_b64 exec, s[76:77]
    global_load_dwordx4 v[152:155], v51, s[26:27] offset:0 sc1
    global_load_dwordx4 v[156:159], v51, s[26:27] offset:128 sc1
    global_load_dwordx4 v[160:163], v51, s[26:27] offset:256 sc1
    global_load_dwordx4 v[164:167], v51, s[26:27] offset:384 sc1
    global_load_dwordx2 v[168:169], v50, s[26:27] offset:512 sc1
    s_waitcnt vmcnt(5) lgkmcnt(0)
    v_xor_b32 v16, s64, v132
    v_bitop3_b32 v16, v16, v133, s65 bitop3:0xf6
    v_bitop3_b32 v16, v16, v134, s66 bitop3:0xf6
    v_bitop3_b32 v16, v16, v135, s67 bitop3:0xf6
    v_bitop3_b32 v16, v16, v136, s64 bitop3:0xf6
    v_bitop3_b32 v16, v16, v137, s65 bitop3:0xf6
    v_bitop3_b32 v16, v16, v138, s66 bitop3:0xf6
    v_bitop3_b32 v16, v16, v139, s67 bitop3:0xf6
    v_bitop3_b32 v16, v16, v140, s64 bitop3:0xf6
    v_bitop3_b32 v16, v16, v141, s65 bitop3:0xf6
    v_bitop3_b32 v16, v16, v142, s66 bitop3:0xf6
    v_bitop3_b32 v16, v16, v143, s67 bitop3:0xf6
    v_bitop3_b32 v16, v16, v144, s64 bitop3:0xf6
    v_bitop3_b32 v16, v16, v145, s65 bitop3:0xf6
    v_bitop3_b32 v16, v16, v146, s66 bitop3:0xf6
    v_bitop3_b32 v16, v16, v147, s67 bitop3:0xf6
    v_bitop3_b32 v16, v16, v148, s64 bitop3:0xf6
    v_bitop3_b32 v16, v16, v149, s65 bitop3:0xf6
    v_and_b32 v16, 31, v16
    v_cmp_eq_u32 vcc, 0, v16
    s_mov_b64 exec, vcc
    v_and_b32 v64, s55, v132
    v_and_b32 v65, s55, v133
    v_and_b32 v66, s55, v134
    v_and_b32 v67, s55, v135
    v_and_b32 v68, s55, v136
    v_and_b32 v69, s55, v137
    v_and_b32 v70, s55, v138
    v_and_b32 v71, s55, v139
    v_and_b32 v72, s55, v140
    v_and_b32 v73, s55, v141
    v_and_b32 v74, s55, v142
    v_and_b32 v75, s55, v143
    v_and_b32 v76, s55, v144
    v_and_b32 v77, s55, v145
    v_and_b32 v78, s55, v146
    v_and_b32 v79, s55, v147
    v_and_b32 v80, s55, v148
    v_and_b32 v81, s55, v149
    s_andn2_b64 s[76:77], s[76:77], vcc
    s_cbranch_scc0 L_ggo_parallel_sum__mha_block_
    s_mov_b64 exec, s[76:77]
    global_load_dwordx4 v[132:135], v51, s[26:27] offset:0 sc1
    global_load_dwordx4 v[136:139], v51, s[26:27] offset:128 sc1
    global_load_dwordx4 v[140:143], v51, s[26:27] offset:256 sc1
    global_load_dwordx4 v[144:147], v51, s[26:27] offset:384 sc1
    global_load_dwordx2 v[148:149], v50, s[26:27] offset:512 sc1
    s_sub_u32 s60, s60, 1
    s_cmp_lg_u32 s60, 0
    s_cbranch_scc1 L_gpoll_parallel_sum__mha_block_
L_ggo_parallel_sum__mha_block_:
    s_mov_b64 exec, -1
    v_mov_b32 v16, v80
    s_nop 1
    v_max_f32_dpp v16, v16, v16 quad_perm:[1,0,3,2] row_mask:0xf bank_mask:0xf
    s_nop 1
    v_max_f32_dpp v16, v16, v16 quad_perm:[2,3,0,1] row_mask:0xf bank_mask:0xf
    s_nop 1
    v_max_f32_dpp v16, v16, v16 row_half_mirror row_mask:0xf bank_mask:0xf
    v_sub_f32 v16, v80, v16
    v_mul_f32 v16, s31, v16
    v_exp_f32 v16, v16
    s_nop 0
    v_mul_f32 v17, v16, v81
    v_mul_f32 v64, v64, v16
    v_mul_f32 v65, v65, v16
    v_mul_f32 v66, v66, v16
    v_add_f32_dpp v17, v17, v17 quad_perm:[1,0,3,2] row_mask:0xf bank_mask:0xf
    v_mul_f32 v67, v67, v16
    v_mul_f32 v68, v68, v16
    v_mul_f32 v69, v69, v16
    v_add_f32_dpp v17, v17, v17 quad_perm:[2,3,0,1] row_mask:0xf bank_mask:0xf
    v_mul_f32 v70, v70, v16
    v_mul_f32 v71, v71, v16
    v_mul_f32 v72, v72, v16
    v_add_f32_dpp v17, v17, v17 row_half_mirror row_mask:0xf bank_mask:0xf
    v_mul_f32 v73, v73, v16
    v_mul_f32 v74, v74, v16
    v_rcp_f32 v18, v17
    v_mul_f32 v75, v75, v16
    v_mul_f32 v76, v76, v16
    v_fma_f32 v19, -v18, v17, 1.0
    v_mul_f32 v77, v77, v16
    v_fma_f32 v18, v19, v18, v18
    v_mul_f32 v78, v78, v16
    v_mul_f32 v79, v79, v16
    v_add_f32_dpp v64, v64, v64 quad_perm:[1,0,3,2] row_mask:0xf bank_mask:0xf
    v_add_f32_dpp v65, v65, v65 quad_perm:[1,0,3,2] row_mask:0xf bank_mask:0xf
    v_add_f32_dpp v66, v66, v66 quad_perm:[1,0,3,2] row_mask:0xf bank_mask:0xf
    v_add_f32_dpp v67, v67, v67 quad_perm:[1,0,3,2] row_mask:0xf bank_mask:0xf
    v_add_f32_dpp v68, v68, v68 quad_perm:[1,0,3,2] row_mask:0xf bank_mask:0xf
    v_add_f32_dpp v69, v69, v69 quad_perm:[1,0,3,2] row_mask:0xf bank_mask:0xf
    v_add_f32_dpp v70, v70, v70 quad_perm:[1,0,3,2] row_mask:0xf bank_mask:0xf
    v_add_f32_dpp v71, v71, v71 quad_perm:[1,0,3,2] row_mask:0xf bank_mask:0xf
    v_add_f32_dpp v72, v72, v72 quad_perm:[1,0,3,2] row_mask:0xf bank_mask:0xf
    v_add_f32_dpp v73, v73, v73 quad_perm:[1,0,3,2] row_mask:0xf bank_mask:0xf
    v_add_f32_dpp v74, v74, v74 quad_perm:[1,0,3,2] row_mask:0xf bank_mask:0xf
    v_add_f32_dpp v75, v75, v75 quad_perm:[1,0,3,2] row_mask:0xf bank_mask:0xf
    v_add_f32_dpp v76, v76, v76 quad_perm:[1,0,3,2] row_mask:0xf bank_mask:0xf
    v_add_f32_dpp v77, v77, v77 quad_perm:[1,0,3,2] row_mask:0xf bank_mask:0xf
    v_add_f32_dpp v78, v78, v78 quad_perm:[1,0,3,2] row_mask:0xf bank_mask:0xf
    v_add_f32_dpp v79, v79, v79 quad_perm:[1,0,3,2] row_mask:0xf bank_mask:0xf
    v_add_f32_dpp v64, v64, v64 quad_perm:[2,3,0,1] row_mask:0xf bank_mask:0xf
    v_add_f32_dpp v65, v65, v65 quad_perm:[2,3,0,1] row_mask:0xf bank_mask:0xf
    v_add_f32_dpp v66, v66, v66 quad_perm:[2,3,0,1] row_mask:0xf bank_mask:0xf
    v_add_f32_dpp v67, v67, v67 quad_perm:[2,3,0,1] row_mask:0xf bank_mask:0xf
    v_add_f32_dpp v68, v68, v68 quad_perm:[2,3,0,1] row_mask:0xf bank_mask:0xf
    v_add_f32_dpp v69, v69, v69 quad_perm:[2,3,0,1] row_mask:0xf bank_mask:0xf
    v_add_f32_dpp v70, v70, v70 quad_perm:[2,3,0,1] row_mask:0xf bank_mask:0xf
    v_add_f32_dpp v71, v71, v71 quad_perm:[2,3,0,1] row_mask:0xf bank_mask:0xf
    v_add_f32_dpp v72, v72, v72 quad_perm:[2,3,0,1] row_mask:0xf bank_mask:0xf
    v_add_f32_dpp v73, v73, v73 quad_perm:[2,3,0,1] row_mask:0xf bank_mask:0xf
    v_add_f32_dpp v74, v74, v74 quad_perm:[2,3,0,1] row_mask:0xf bank_mask:0xf
    v_add_f32_dpp v75, v75, v75 quad_perm:[2,3,0,1] row_mask:0xf bank_mask:0xf
    v_add_f32_dpp v76, v76, v76 quad_perm:[2,3,0,1] row_mask:0xf bank_mask:0xf
    v_add_f32_dpp v77, v77, v77 quad_perm:[2,3,0,1] row_mask:0xf bank_mask:0xf
    v_add_f32_dpp v78, v78, v78 quad_perm:[2,3,0,1] row_mask:0xf bank_mask:0xf
    v_add_f32_dpp v79, v79, v79 quad_perm:[2,3,0,1] row_mask:0xf bank_mask:0xf
    v_add_f32_dpp v64, v64, v64 row_half_mirror row_mask:0xf bank_mask:0xf
    v_add_f32_dpp v65, v65, v65 row_half_mirror row_mask:0xf bank_mask:0xf
    v_add_f32_dpp v66, v66, v66 row_half_mirror row_mask:0xf bank_mask:0xf
    v_add_f32_dpp v67, v67, v67 row_half_mirror row_mask:0xf bank_mask:0xf
    v_add_f32_dpp v68, v68, v68 row_half_mirror row_mask:0xf bank_mask:0xf
    v_add_f32_dpp v69, v69, v69 row_half_mirror row_mask:0xf bank_mask:0xf
    v_add_f32_dpp v70, v70, v70 row_half_mirror row_mask:0xf bank_mask:0xf
    v_add_f32_dpp v71, v71, v71 row_half_mirror row_mask:0xf bank_mask:0xf
    v_add_f32_dpp v72, v72, v72 row_half_mirror row_mask:0xf bank_mask:0xf
    v_add_f32_dpp v73, v73, v73 row_half_mirror row_mask:0xf bank_mask:0xf
    v_add_f32_dpp v74, v74, v74 row_half_mirror row_mask:0xf bank_mask:0xf
    v_add_f32_dpp v75, v75, v75 row_half_mirror row_mask:0xf bank_mask:0xf
    v_add_f32_dpp v76, v76, v76 row_half_mirror row_mask:0xf bank_mask:0xf
    v_add_f32_dpp v77, v77, v77 row_half_mirror row_mask:0xf bank_mask:0xf
    v_add_f32_dpp v78, v78, v78 row_half_mirror row_mask:0xf bank_mask:0xf
    v_add_f32_dpp v79, v79, v79 row_half_mirror row_mask:0xf bank_mask:0xf
    v_mul_f32 v64, v64, v18
    v_cvt_pk_bf16_f32 v64, v64, v64
    v_and_b32 v84, v64, v4
    v_and_b32 v85, v64, v5
    v_and_b32 v86, v64, v6
    v_and_b32 v87, v64, v7
    v_mul_f32 v65, v65, v18
    v_cvt_pk_bf16_f32 v65, v65, v65
    v_and_b32 v88, v65, v4
    v_and_b32 v89, v65, v5
    v_and_b32 v90, v65, v6
    v_and_b32 v91, v65, v7
    v_mfma_f32_16x16x32_bf16 v[8:11], v[84:87], v[192:195], 0
    v_mul_f32 v66, v66, v18
    v_cvt_pk_bf16_f32 v66, v66, v66
    v_and_b32 v92, v66, v4
    v_and_b32 v93, v66, v5
    v_and_b32 v94, v66, v6
    v_and_b32 v95, v66, v7
    v_mfma_f32_16x16x32_bf16 v[12:15], v[88:91], v[196:199], 0
    v_mul_f32 v67, v67, v18
    v_cvt_pk_bf16_f32 v67, v67, v67
    v_and_b32 v96, v67, v4
    v_and_b32 v97, v67, v5
    v_and_b32 v98, v67, v6
    v_and_b32 v99, v67, v7
    v_mfma_f32_16x16x32_bf16 v[8:11], v[92:95], v[200:203], v[8:11]
    v_mul_f32 v68, v68, v18
    v_cvt_pk_bf16_f32 v68, v68, v68
    v_and_b32 v84, v68, v4
    v_and_b32 v85, v68, v5
    v_and_b32 v86, v68, v6
    v_and_b32 v87, v68, v7
    v_mfma_f32_16x16x32_bf16 v[12:15], v[96:99], v[204:207], v[12:15]
    v_mul_f32 v69, v69, v18
    v_cvt_pk_bf16_f32 v69, v69, v69
    v_and_b32 v88, v69, v4
    v_and_b32 v89, v69, v5
    v_and_b32 v90, v69, v6
    v_and_b32 v91, v69, v7
    v_mfma_f32_16x16x32_bf16 v[8:11], v[84:87], v[208:211], v[8:11]
    v_mul_f32 v70, v70, v18
    v_cvt_pk_bf16_f32 v70, v70, v70
    v_and_b32 v92, v70, v4
    v_and_b32 v93, v70, v5
    v_and_b32 v94, v70, v6
    v_and_b32 v95, v70, v7
    v_mfma_f32_16x16x32_bf16 v[12:15], v[88:91], v[212:215], v[12:15]
    v_mul_f32 v71, v71, v18
    v_cvt_pk_bf16_f32 v71, v71, v71
    v_and_b32 v96, v71, v4
    v_and_b32 v97, v71, v5
    v_and_b32 v98, v71, v6
    v_and_b32 v99, v71, v7
    v_mfma_f32_16x16x32_bf16 v[8:11], v[92:95], v[216:219], v[8:11]
    v_mul_f32 v72, v72, v18
    v_cvt_pk_bf16_f32 v72, v72, v72
    v_and_b32 v84, v72, v4
    v_and_b32 v85, v72, v5
    v_and_b32 v86, v72, v6
    v_and_b32 v87, v72, v7
    v_mfma_f32_16x16x32_bf16 v[12:15], v[96:99], v[220:223], v[12:15]
    v_mul_f32 v73, v73, v18
    v_cvt_pk_bf16_f32 v73, v73, v73
    v_and_b32 v88, v73, v4
    v_and_b32 v89, v73, v5
    v_and_b32 v90, v73, v6
    v_and_b32 v91, v73, v7
    v_mfma_f32_16x16x32_bf16 v[8:11], v[84:87], v[224:227], v[8:11]
    v_mul_f32 v74, v74, v18
    v_cvt_pk_bf16_f32 v74, v74, v74
    v_and_b32 v92, v74, v4
    v_and_b32 v93, v74, v5
    v_and_b32 v94, v74, v6
    v_and_b32 v95, v74, v7
    v_mfma_f32_16x16x32_bf16 v[12:15], v[88:91], v[228:231], v[12:15]
    v_mul_f32 v75, v75, v18
    v_cvt_pk_bf16_f32 v75, v75, v75
    v_and_b32 v96, v75, v4
    v_and_b32 v97, v75, v5
    v_and_b32 v98, v75, v6
    v_and_b32 v99, v75, v7
    v_mfma_f32_16x16x32_bf16 v[8:11], v[92:95], v[232:235], v[8:11]
    v_mul_f32 v76, v76, v18
    v_cvt_pk_bf16_f32 v76, v76, v76
    v_and_b32 v84, v76, v4
    v_and_b32 v85, v76, v5
    v_and_b32 v86, v76, v6
    v_and_b32 v87, v76, v7
    v_mfma_f32_16x16x32_bf16 v[12:15], v[96:99], v[236:239], v[12:15]
    v_mul_f32 v77, v77, v18
    v_cvt_pk_bf16_f32 v77, v77, v77
    v_and_b32 v88, v77, v4
    v_and_b32 v89, v77, v5
    v_and_b32 v90, v77, v6
    v_and_b32 v91, v77, v7
    v_mfma_f32_16x16x32_bf16 v[8:11], v[84:87], v[240:243], v[8:11]
    v_mul_f32 v78, v78, v18
    v_cvt_pk_bf16_f32 v78, v78, v78
    v_and_b32 v92, v78, v4
    v_and_b32 v93, v78, v5
    v_and_b32 v94, v78, v6
    v_and_b32 v95, v78, v7
    v_mfma_f32_16x16x32_bf16 v[12:15], v[88:91], v[244:247], v[12:15]
    v_mul_f32 v79, v79, v18
    v_cvt_pk_bf16_f32 v79, v79, v79
    v_and_b32 v96, v79, v4
    v_and_b32 v97, v79, v5
    v_and_b32 v98, v79, v6
    v_and_b32 v99, v79, v7
    v_mfma_f32_16x16x32_bf16 v[8:11], v[92:95], v[248:251], v[8:11]
    s_nop 1
    v_mfma_f32_16x16x32_bf16 v[12:15], v[96:99], v[252:255], v[12:15]
    s_nop 7
    v_add_f32 v8, v8, v12
    v_add_f32 v9, v9, v13
    v_add_f32 v10, v10, v14
    v_add_f32 v11, v11, v15
    v_mov_b32_dpp v16, v8 row_ror:8 row_mask:0xf bank_mask:0xf
    v_mov_b32_dpp v17, v9 row_ror:8 row_mask:0xf bank_mask:0xf
    v_mov_b32_dpp v18, v10 row_ror:8 row_mask:0xf bank_mask:0xf
    v_mov_b32_dpp v19, v11 row_ror:8 row_mask:0xf bank_mask:0xf
    s_nop 1
    v_permlane32_swap_b32 v16, v20
    v_permlane32_swap_b32 v17, v21
    v_permlane32_swap_b32 v18, v22
    v_permlane32_swap_b32 v19, v23
    s_nop 1
    v_add_f32 v8, v8, v20
    v_add_f32 v9, v9, v21
    v_add_f32 v10, v10, v22
    v_add_f32 v11, v11, v23
    v_bfi_b32 v8, v57, v8, s64
    v_bfi_b32 v9, v57, v9, s65
    v_bfi_b32 v10, v57, v10, s66
    v_bfi_b32 v11, v57, v11, s67
    s_mov_b64 exec, 0x00ff00ff
    global_store_dwordx4 v44, v[8:11], s[26:27] sc1
L_end_parallel_sum__mha_block_:
s_endpgm
.section .rodata,"a"
.p2align 6
.amdhsa_kernel parallel_sum__mha_block_cached__glu_gated_reglu__decode_kernel
  .amdhsa_next_free_vgpr 448
  .amdhsa_next_free_sgpr 102
  .amdhsa_accum_offset 256
  .amdhsa_group_segment_fixed_size 0
  .amdhsa_kernarg_size 96
  .amdhsa_user_sgpr_count 2
  .amdhsa_user_sgpr_kernarg_segment_ptr 1
  .amdhsa_system_sgpr_workgroup_id_x 1
  .amdhsa_float_denorm_mode_32 3
.end_amdhsa_kernel
```
